```python
import torch

def _softmax(x, axis=-1):
    return torch.softmax(x, dim=axis)
def _gelu(x):
    return torch.nn.functional.gelu(x, approximate="tanh")
def _silu(x):
    return torch.nn.functional.silu(x)
def _sigmoid(x):
    return torch.sigmoid(x)
def _layernorm(x, axis=-1, eps=1e-5):
    m = x.mean(dim=axis, keepdim=True)
    v = x.var(dim=axis, keepdim=True, unbiased=False)
    return (x - m) / torch.sqrt(v + eps)
def _scatter_add(tgt, idx, src, axis=0):
    return tgt.clone().index_add_(axis, idx, src)
def _segment_sum(src, seg, n):
    out = torch.zeros((n,) + src.shape[1:], dtype=src.dtype)
    return out.index_add_(0, seg, src)
def _pad(x, pw):
    flat = tuple(v for pair in reversed(pw) for v in pair)
    return torch.nn.functional.pad(x, flat)

kernel_name = 'standalone__dense_activation_squared_relu__prompt'

def setup_inputs():

    _w = (lambda a: (lambda t: t.to(torch.bfloat16) if t.is_floating_point() else t)(torch.as_tensor(a)))
    B, S, D, F = 1, 2048, 640, 1728
    return {
        "x": _w((lambda *s: torch.randn(*s, dtype=torch.bfloat16) * 0.05)(B, S, D)),
        "w1": _w((lambda *s: torch.randn(*s, dtype=torch.bfloat16) * 0.05)(D, F)),
        "b1": _w((lambda *s: torch.randn(*s, dtype=torch.bfloat16) * 0.05)(F)),
        "w2": _w((lambda *s: torch.randn(*s, dtype=torch.bfloat16) * 0.05)(F, D)),
        "b2": _w((lambda *s: torch.randn(*s, dtype=torch.bfloat16) * 0.05)(D)),
    }

def reference(x, w1, b1, w2, b2):
    h = torch.einsum("bsd,df->bsf", x, w1) + b1
    zero = torch.zeros_like(h)
    r = torch.where(h > zero, h, zero)
    h = r * r
    out = torch.einsum("bsf,fd->bsd", h, w2) + b2
    return out
```

```asm
; @launch kernel=ffn1_kernel grid=(224,1,1) block=(512,1,1) lds=163840
; @launch kernel=ffn2_kernel grid=(224,1,1) block=(512,1,1) lds=163840
.amdgcn_target "amdgcn-amd-amdhsa--gfx950"
.text
.globl ffn1_kernel
.p2align 8
.type ffn1_kernel,@function
ffn1_kernel:
    s_cmp_ge_u32 s2, 224
    s_cbranch_scc1 L_ffn1_kernel_end
    s_load_dwordx2 s[4:5], s[0:1], 0
    s_load_dwordx2 s[8:9], s[0:1], 8
    s_load_dwordx2 s[12:13], s[0:1], 16
    s_load_dwordx2 s[16:17], s[0:1], 56
    s_and_b32 s24, s2, 7
    s_lshr_b32 s25, s2, 3
    s_mul_i32 s26, s25, 37
    s_lshr_b32 s26, s26, 8
    s_mul_i32 s27, s26, 7
    s_sub_u32 s27, s25, s27
    s_lshr_b32 s25, s24, 1
    s_lshl_b32 s25, s25, 2
    s_add_u32 s26, s26, s25
    s_and_b32 s24, s24, 1
    s_mul_i32 s24, s24, 7
    s_add_u32 s27, s27, s24
    s_lshr_b32 s31, s2, 3
    s_cmp_ge_u32 s31, 10
    s_cselect_b32 s24, 10, 0
    s_sub_u32 s31, s31, s24
    s_cmp_ge_u32 s31, 10
    s_cselect_b32 s24, 10, 0
    s_sub_u32 s31, s31, s24
    s_cmp_ge_u32 s31, 10
    s_cselect_b32 s24, 10, 0
    s_sub_u32 s31, s31, s24
    s_mul_i32 s29, s31, 221184
    s_lshl_b32 s30, s31, 7
    s_mul_i32 s22, s26, 128
    s_mul_i32 s23, s27, 128
    v_and_b32 v1, 63, v0
    v_lshrrev_b32 v2, 4, v1
    v_and_b32 v3, 15, v1
    v_lshrrev_b32 v4, 6, v0
    s_nop 1
    v_readfirstlane_b32 s32, v4
    v_and_b32 v4, 3, v4
    s_lshl_b32 s24, s23, 1
    s_cmp_ge_u32 s32, 4
    s_cbranch_scc1 L_ffn1_kernel_loader
    v_and_b32 v30, 0, v4
    v_lshrrev_b32 v4, 0, v4
    v_lshrrev_b32 v6, 1, v3
    v_mul_u32_u24 v5, 4096, v4
    v_lshl_add_u32 v5, v3, 7, v5
    v_xor_b32 v7, 0, v2
    v_xor_b32 v7, v7, v6
    v_lshl_add_u32 v16, v7, 4, v5
    v_xor_b32 v7, 4, v2
    v_xor_b32 v7, v7, v6
    v_lshl_add_u32 v17, v7, 4, v5
    v_bfe_u32 v5, v1, 2, 2
    v_and_b32 v6, 1, v2
    v_lshl_add_u32 v6, v6, 2, v5
    v_lshl_add_u32 v5, v2, 3, v5
    v_lshlrev_b32 v5, 8, v5
    v_and_b32 v7, 3, v1
    v_lshl_add_u32 v5, v7, 3, v5
    v_add_u32 v5, 16384, v5
    v_mul_u32_u24 v7, 8, v30
    v_add_u32 v18, 0, v7
    v_xor_b32 v18, v18, v6
    v_lshl_add_u32 v18, v18, 5, v5
    v_add_u32 v19, 1, v7
    v_xor_b32 v19, v19, v6
    v_lshl_add_u32 v19, v19, 5, v5
    v_add_u32 v20, 2, v7
    v_xor_b32 v20, v20, v6
    v_lshl_add_u32 v20, v20, 5, v5
    v_add_u32 v21, 3, v7
    v_xor_b32 v21, v21, v6
    v_lshl_add_u32 v21, v21, 5, v5
    v_add_u32 v22, 4, v7
    v_xor_b32 v22, v22, v6
    v_lshl_add_u32 v22, v22, 5, v5
    v_add_u32 v23, 5, v7
    v_xor_b32 v23, v23, v6
    v_lshl_add_u32 v23, v23, 5, v5
    v_add_u32 v24, 6, v7
    v_xor_b32 v24, v24, v6
    v_lshl_add_u32 v24, v24, 5, v5
    v_add_u32 v25, 7, v7
    v_xor_b32 v25, v25, v6
    v_lshl_add_u32 v25, v25, 5, v5
    v_lshlrev_b32 v27, 8, v30
    v_lshl_add_u32 v27, v2, 3, v27
    v_add_u32 v27, s24, v27
    s_waitcnt lgkmcnt(0)
    s_mov_b32 s14, 3456
    s_mov_b32 s15, 0x00020000
    s_mov_b32 s18, 7077888
    s_mov_b32 s19, 0x00020000
    buffer_load_dwordx2 v[32:33], v27, s[12:15], 0 offen offset:0
    buffer_load_dwordx2 v[34:35], v27, s[12:15], 0 offen offset:32
    buffer_load_dwordx2 v[36:37], v27, s[12:15], 0 offen offset:64
    buffer_load_dwordx2 v[38:39], v27, s[12:15], 0 offen offset:96
    buffer_load_dwordx2 v[40:41], v27, s[12:15], 0 offen offset:128
    buffer_load_dwordx2 v[42:43], v27, s[12:15], 0 offen offset:160
    buffer_load_dwordx2 v[44:45], v27, s[12:15], 0 offen offset:192
    buffer_load_dwordx2 v[46:47], v27, s[12:15], 0 offen offset:224
    v_mul_u32_u24 v26, 32, v4
    v_add_u32 v26, v26, v3
    v_mul_u32_u24 v26, 272, v26
    v_mul_u32_u24 v5, 256, v30
    v_lshl_add_u32 v5, v2, 3, v5
    v_add_u32 v26, v26, v5
    v_lshrrev_b32 v4, 6, v0
    v_mul_u32_u24 v4, 32, v4
    v_lshrrev_b32 v5, 4, v1
    v_add_u32 v5, v5, v4
    v_and_b32 v6, 15, v1
    v_mul_u32_u24 v28, 272, v5
    v_lshl_add_u32 v28, v6, 4, v28
    v_add_u32 v5, s22, v5
    v_mul_u32_u24 v29, 3456, v5
    v_lshl_add_u32 v7, v6, 4, s24
    v_add_u32 v29, v29, v7
    s_cmp_eq_u32 s27, 13
    s_cselect_b32 s25, 8, 16
    v_cmp_gt_u32 vcc, s25, v6
    v_bfrev_b32 v7, 1
    s_nop 0
    v_cndmask_b32 v29, v7, v29, vcc
    s_waitcnt vmcnt(0)
    v_lshlrev_b32 v48, 16, v32
    v_and_b32 v49, 0xffff0000, v32
    v_lshlrev_b32 v50, 16, v33
    v_and_b32 v51, 0xffff0000, v33
    v_lshlrev_b32 v80, 16, v32
    v_and_b32 v81, 0xffff0000, v32
    v_lshlrev_b32 v82, 16, v33
    v_and_b32 v83, 0xffff0000, v33
    v_lshlrev_b32 v52, 16, v34
    v_and_b32 v53, 0xffff0000, v34
    v_lshlrev_b32 v54, 16, v35
    v_and_b32 v55, 0xffff0000, v35
    v_lshlrev_b32 v84, 16, v34
    v_and_b32 v85, 0xffff0000, v34
    v_lshlrev_b32 v86, 16, v35
    v_and_b32 v87, 0xffff0000, v35
    v_lshlrev_b32 v56, 16, v36
    v_and_b32 v57, 0xffff0000, v36
    v_lshlrev_b32 v58, 16, v37
    v_and_b32 v59, 0xffff0000, v37
    v_lshlrev_b32 v88, 16, v36
    v_and_b32 v89, 0xffff0000, v36
    v_lshlrev_b32 v90, 16, v37
    v_and_b32 v91, 0xffff0000, v37
    v_lshlrev_b32 v60, 16, v38
    v_and_b32 v61, 0xffff0000, v38
    v_lshlrev_b32 v62, 16, v39
    v_and_b32 v63, 0xffff0000, v39
    v_lshlrev_b32 v92, 16, v38
    v_and_b32 v93, 0xffff0000, v38
    v_lshlrev_b32 v94, 16, v39
    v_and_b32 v95, 0xffff0000, v39
    v_lshlrev_b32 v64, 16, v40
    v_and_b32 v65, 0xffff0000, v40
    v_lshlrev_b32 v66, 16, v41
    v_and_b32 v67, 0xffff0000, v41
    v_lshlrev_b32 v96, 16, v40
    v_and_b32 v97, 0xffff0000, v40
    v_lshlrev_b32 v98, 16, v41
    v_and_b32 v99, 0xffff0000, v41
    v_lshlrev_b32 v68, 16, v42
    v_and_b32 v69, 0xffff0000, v42
    v_lshlrev_b32 v70, 16, v43
    v_and_b32 v71, 0xffff0000, v43
    v_lshlrev_b32 v100, 16, v42
    v_and_b32 v101, 0xffff0000, v42
    v_lshlrev_b32 v102, 16, v43
    v_and_b32 v103, 0xffff0000, v43
    v_lshlrev_b32 v72, 16, v44
    v_and_b32 v73, 0xffff0000, v44
    v_lshlrev_b32 v74, 16, v45
    v_and_b32 v75, 0xffff0000, v45
    v_lshlrev_b32 v104, 16, v44
    v_and_b32 v105, 0xffff0000, v44
    v_lshlrev_b32 v106, 16, v45
    v_and_b32 v107, 0xffff0000, v45
    v_lshlrev_b32 v76, 16, v46
    v_and_b32 v77, 0xffff0000, v46
    v_lshlrev_b32 v78, 16, v47
    v_and_b32 v79, 0xffff0000, v47
    v_lshlrev_b32 v108, 16, v46
    v_and_b32 v109, 0xffff0000, v46
    v_lshlrev_b32 v110, 16, v47
    v_and_b32 v111, 0xffff0000, v47
    s_barrier
    ds_read_b128 v[176:179], v16 offset:0
    ds_read_b128 v[180:183], v16 offset:2048
    ds_read_b64_tr_b16 v[112:113], v18 offset:0
    ds_read_b64_tr_b16 v[114:115], v18 offset:1024
    ds_read_b64_tr_b16 v[116:117], v19 offset:0
    ds_read_b64_tr_b16 v[118:119], v19 offset:1024
    ds_read_b64_tr_b16 v[120:121], v20 offset:0
    ds_read_b64_tr_b16 v[122:123], v20 offset:1024
    ds_read_b64_tr_b16 v[124:125], v21 offset:0
    ds_read_b64_tr_b16 v[126:127], v21 offset:1024
    ds_read_b64_tr_b16 v[128:129], v22 offset:0
    ds_read_b64_tr_b16 v[130:131], v22 offset:1024
    ds_read_b64_tr_b16 v[132:133], v23 offset:0
    ds_read_b64_tr_b16 v[134:135], v23 offset:1024
    ds_read_b64_tr_b16 v[136:137], v24 offset:0
    ds_read_b64_tr_b16 v[138:139], v24 offset:1024
    ds_read_b64_tr_b16 v[140:141], v25 offset:0
    ds_read_b64_tr_b16 v[142:143], v25 offset:1024
    s_waitcnt lgkmcnt(0)
    v_mfma_f32_16x16x32_bf16 v[48:51], v[112:115], v[176:179], v[48:51]
    ds_read_b128 v[184:187], v17 offset:0
    ds_read_b128 v[188:191], v17 offset:2048
    v_mfma_f32_16x16x32_bf16 v[52:55], v[116:119], v[176:179], v[52:55]
    ds_read_b64_tr_b16 v[144:145], v18 offset:8192
    ds_read_b64_tr_b16 v[146:147], v18 offset:9216
    v_mfma_f32_16x16x32_bf16 v[56:59], v[120:123], v[176:179], v[56:59]
    ds_read_b64_tr_b16 v[148:149], v19 offset:8192
    v_mfma_f32_16x16x32_bf16 v[60:63], v[124:127], v[176:179], v[60:63]
    ds_read_b64_tr_b16 v[150:151], v19 offset:9216
    v_mfma_f32_16x16x32_bf16 v[64:67], v[128:131], v[176:179], v[64:67]
    ds_read_b64_tr_b16 v[152:153], v20 offset:8192
    v_mfma_f32_16x16x32_bf16 v[68:71], v[132:135], v[176:179], v[68:71]
    ds_read_b64_tr_b16 v[154:155], v20 offset:9216
    v_mfma_f32_16x16x32_bf16 v[72:75], v[136:139], v[176:179], v[72:75]
    ds_read_b64_tr_b16 v[156:157], v21 offset:8192
    v_mfma_f32_16x16x32_bf16 v[76:79], v[140:143], v[176:179], v[76:79]
    ds_read_b64_tr_b16 v[158:159], v21 offset:9216
    v_mfma_f32_16x16x32_bf16 v[80:83], v[112:115], v[180:183], v[80:83]
    ds_read_b64_tr_b16 v[160:161], v22 offset:8192
    v_mfma_f32_16x16x32_bf16 v[84:87], v[116:119], v[180:183], v[84:87]
    ds_read_b64_tr_b16 v[162:163], v22 offset:9216
    v_mfma_f32_16x16x32_bf16 v[88:91], v[120:123], v[180:183], v[88:91]
    ds_read_b64_tr_b16 v[164:165], v23 offset:8192
    v_mfma_f32_16x16x32_bf16 v[92:95], v[124:127], v[180:183], v[92:95]
    ds_read_b64_tr_b16 v[166:167], v23 offset:9216
    v_mfma_f32_16x16x32_bf16 v[96:99], v[128:131], v[180:183], v[96:99]
    ds_read_b64_tr_b16 v[168:169], v24 offset:8192
    v_mfma_f32_16x16x32_bf16 v[100:103], v[132:135], v[180:183], v[100:103]
    ds_read_b64_tr_b16 v[170:171], v24 offset:9216
    v_mfma_f32_16x16x32_bf16 v[104:107], v[136:139], v[180:183], v[104:107]
    ds_read_b64_tr_b16 v[172:173], v25 offset:8192
    v_mfma_f32_16x16x32_bf16 v[108:111], v[140:143], v[180:183], v[108:111]
    ds_read_b64_tr_b16 v[174:175], v25 offset:9216
    s_barrier
    v_add_u32 v16, 0x8000, v16
    v_add_u32 v17, 0x8000, v17
    v_add_u32 v18, 0x8000, v18
    v_add_u32 v19, 0x8000, v19
    v_add_u32 v20, 0x8000, v20
    v_add_u32 v21, 0x8000, v21
    v_add_u32 v22, 0x8000, v22
    v_add_u32 v23, 0x8000, v23
    v_add_u32 v24, 0x8000, v24
    v_add_u32 v25, 0x8000, v25
    s_waitcnt lgkmcnt(0)
    v_mfma_f32_16x16x32_bf16 v[48:51], v[144:147], v[184:187], v[48:51]
    ds_read_b128 v[176:179], v16 offset:0
    ds_read_b128 v[180:183], v16 offset:2048
    v_mfma_f32_16x16x32_bf16 v[52:55], v[148:151], v[184:187], v[52:55]
    ds_read_b64_tr_b16 v[112:113], v18 offset:0
    ds_read_b64_tr_b16 v[114:115], v18 offset:1024
    v_mfma_f32_16x16x32_bf16 v[56:59], v[152:155], v[184:187], v[56:59]
    ds_read_b64_tr_b16 v[116:117], v19 offset:0
    v_mfma_f32_16x16x32_bf16 v[60:63], v[156:159], v[184:187], v[60:63]
    ds_read_b64_tr_b16 v[118:119], v19 offset:1024
    v_mfma_f32_16x16x32_bf16 v[64:67], v[160:163], v[184:187], v[64:67]
    ds_read_b64_tr_b16 v[120:121], v20 offset:0
    v_mfma_f32_16x16x32_bf16 v[68:71], v[164:167], v[184:187], v[68:71]
    ds_read_b64_tr_b16 v[122:123], v20 offset:1024
    v_mfma_f32_16x16x32_bf16 v[72:75], v[168:171], v[184:187], v[72:75]
    ds_read_b64_tr_b16 v[124:125], v21 offset:0
    v_mfma_f32_16x16x32_bf16 v[76:79], v[172:175], v[184:187], v[76:79]
    ds_read_b64_tr_b16 v[126:127], v21 offset:1024
    v_mfma_f32_16x16x32_bf16 v[80:83], v[144:147], v[188:191], v[80:83]
    ds_read_b64_tr_b16 v[128:129], v22 offset:0
    v_mfma_f32_16x16x32_bf16 v[84:87], v[148:151], v[188:191], v[84:87]
    ds_read_b64_tr_b16 v[130:131], v22 offset:1024
    v_mfma_f32_16x16x32_bf16 v[88:91], v[152:155], v[188:191], v[88:91]
    ds_read_b64_tr_b16 v[132:133], v23 offset:0
    v_mfma_f32_16x16x32_bf16 v[92:95], v[156:159], v[188:191], v[92:95]
    ds_read_b64_tr_b16 v[134:135], v23 offset:1024
    v_mfma_f32_16x16x32_bf16 v[96:99], v[160:163], v[188:191], v[96:99]
    ds_read_b64_tr_b16 v[136:137], v24 offset:0
    v_mfma_f32_16x16x32_bf16 v[100:103], v[164:167], v[188:191], v[100:103]
    ds_read_b64_tr_b16 v[138:139], v24 offset:1024
    v_mfma_f32_16x16x32_bf16 v[104:107], v[168:171], v[188:191], v[104:107]
    ds_read_b64_tr_b16 v[140:141], v25 offset:0
    v_mfma_f32_16x16x32_bf16 v[108:111], v[172:175], v[188:191], v[108:111]
    ds_read_b64_tr_b16 v[142:143], v25 offset:1024
    s_waitcnt lgkmcnt(0)
    v_mfma_f32_16x16x32_bf16 v[48:51], v[112:115], v[176:179], v[48:51]
    ds_read_b128 v[184:187], v17 offset:0
    ds_read_b128 v[188:191], v17 offset:2048
    v_mfma_f32_16x16x32_bf16 v[52:55], v[116:119], v[176:179], v[52:55]
    ds_read_b64_tr_b16 v[144:145], v18 offset:8192
    ds_read_b64_tr_b16 v[146:147], v18 offset:9216
    v_mfma_f32_16x16x32_bf16 v[56:59], v[120:123], v[176:179], v[56:59]
    ds_read_b64_tr_b16 v[148:149], v19 offset:8192
    v_mfma_f32_16x16x32_bf16 v[60:63], v[124:127], v[176:179], v[60:63]
    ds_read_b64_tr_b16 v[150:151], v19 offset:9216
    v_mfma_f32_16x16x32_bf16 v[64:67], v[128:131], v[176:179], v[64:67]
    ds_read_b64_tr_b16 v[152:153], v20 offset:8192
    v_mfma_f32_16x16x32_bf16 v[68:71], v[132:135], v[176:179], v[68:71]
    ds_read_b64_tr_b16 v[154:155], v20 offset:9216
    v_mfma_f32_16x16x32_bf16 v[72:75], v[136:139], v[176:179], v[72:75]
    ds_read_b64_tr_b16 v[156:157], v21 offset:8192
    v_mfma_f32_16x16x32_bf16 v[76:79], v[140:143], v[176:179], v[76:79]
    ds_read_b64_tr_b16 v[158:159], v21 offset:9216
    v_mfma_f32_16x16x32_bf16 v[80:83], v[112:115], v[180:183], v[80:83]
    ds_read_b64_tr_b16 v[160:161], v22 offset:8192
    v_mfma_f32_16x16x32_bf16 v[84:87], v[116:119], v[180:183], v[84:87]
    ds_read_b64_tr_b16 v[162:163], v22 offset:9216
    v_mfma_f32_16x16x32_bf16 v[88:91], v[120:123], v[180:183], v[88:91]
    ds_read_b64_tr_b16 v[164:165], v23 offset:8192
    v_mfma_f32_16x16x32_bf16 v[92:95], v[124:127], v[180:183], v[92:95]
    ds_read_b64_tr_b16 v[166:167], v23 offset:9216
    v_mfma_f32_16x16x32_bf16 v[96:99], v[128:131], v[180:183], v[96:99]
    ds_read_b64_tr_b16 v[168:169], v24 offset:8192
    v_mfma_f32_16x16x32_bf16 v[100:103], v[132:135], v[180:183], v[100:103]
    ds_read_b64_tr_b16 v[170:171], v24 offset:9216
    v_mfma_f32_16x16x32_bf16 v[104:107], v[136:139], v[180:183], v[104:107]
    ds_read_b64_tr_b16 v[172:173], v25 offset:8192
    v_mfma_f32_16x16x32_bf16 v[108:111], v[140:143], v[180:183], v[108:111]
    ds_read_b64_tr_b16 v[174:175], v25 offset:9216
    s_barrier
    v_add_u32 v16, 0x8000, v16
    v_add_u32 v17, 0x8000, v17
    v_add_u32 v18, 0x8000, v18
    v_add_u32 v19, 0x8000, v19
    v_add_u32 v20, 0x8000, v20
    v_add_u32 v21, 0x8000, v21
    v_add_u32 v22, 0x8000, v22
    v_add_u32 v23, 0x8000, v23
    v_add_u32 v24, 0x8000, v24
    v_add_u32 v25, 0x8000, v25
    s_waitcnt lgkmcnt(0)
    v_mfma_f32_16x16x32_bf16 v[48:51], v[144:147], v[184:187], v[48:51]
    ds_read_b128 v[176:179], v16 offset:0
    ds_read_b128 v[180:183], v16 offset:2048
    v_mfma_f32_16x16x32_bf16 v[52:55], v[148:151], v[184:187], v[52:55]
    ds_read_b64_tr_b16 v[112:113], v18 offset:0
    ds_read_b64_tr_b16 v[114:115], v18 offset:1024
    v_mfma_f32_16x16x32_bf16 v[56:59], v[152:155], v[184:187], v[56:59]
    ds_read_b64_tr_b16 v[116:117], v19 offset:0
    v_mfma_f32_16x16x32_bf16 v[60:63], v[156:159], v[184:187], v[60:63]
    ds_read_b64_tr_b16 v[118:119], v19 offset:1024
    v_mfma_f32_16x16x32_bf16 v[64:67], v[160:163], v[184:187], v[64:67]
    ds_read_b64_tr_b16 v[120:121], v20 offset:0
    v_mfma_f32_16x16x32_bf16 v[68:71], v[164:167], v[184:187], v[68:71]
    ds_read_b64_tr_b16 v[122:123], v20 offset:1024
    v_mfma_f32_16x16x32_bf16 v[72:75], v[168:171], v[184:187], v[72:75]
    ds_read_b64_tr_b16 v[124:125], v21 offset:0
    v_mfma_f32_16x16x32_bf16 v[76:79], v[172:175], v[184:187], v[76:79]
    ds_read_b64_tr_b16 v[126:127], v21 offset:1024
    v_mfma_f32_16x16x32_bf16 v[80:83], v[144:147], v[188:191], v[80:83]
    ds_read_b64_tr_b16 v[128:129], v22 offset:0
    v_mfma_f32_16x16x32_bf16 v[84:87], v[148:151], v[188:191], v[84:87]
    ds_read_b64_tr_b16 v[130:131], v22 offset:1024
    v_mfma_f32_16x16x32_bf16 v[88:91], v[152:155], v[188:191], v[88:91]
    ds_read_b64_tr_b16 v[132:133], v23 offset:0
    v_mfma_f32_16x16x32_bf16 v[92:95], v[156:159], v[188:191], v[92:95]
    ds_read_b64_tr_b16 v[134:135], v23 offset:1024
    v_mfma_f32_16x16x32_bf16 v[96:99], v[160:163], v[188:191], v[96:99]
    ds_read_b64_tr_b16 v[136:137], v24 offset:0
    v_mfma_f32_16x16x32_bf16 v[100:103], v[164:167], v[188:191], v[100:103]
    ds_read_b64_tr_b16 v[138:139], v24 offset:1024
    v_mfma_f32_16x16x32_bf16 v[104:107], v[168:171], v[188:191], v[104:107]
    ds_read_b64_tr_b16 v[140:141], v25 offset:0
    v_mfma_f32_16x16x32_bf16 v[108:111], v[172:175], v[188:191], v[108:111]
    ds_read_b64_tr_b16 v[142:143], v25 offset:1024
    s_waitcnt lgkmcnt(0)
    v_mfma_f32_16x16x32_bf16 v[48:51], v[112:115], v[176:179], v[48:51]
    ds_read_b128 v[184:187], v17 offset:0
    ds_read_b128 v[188:191], v17 offset:2048
    v_mfma_f32_16x16x32_bf16 v[52:55], v[116:119], v[176:179], v[52:55]
    ds_read_b64_tr_b16 v[144:145], v18 offset:8192
    ds_read_b64_tr_b16 v[146:147], v18 offset:9216
    v_mfma_f32_16x16x32_bf16 v[56:59], v[120:123], v[176:179], v[56:59]
    ds_read_b64_tr_b16 v[148:149], v19 offset:8192
    v_mfma_f32_16x16x32_bf16 v[60:63], v[124:127], v[176:179], v[60:63]
    ds_read_b64_tr_b16 v[150:151], v19 offset:9216
    v_mfma_f32_16x16x32_bf16 v[64:67], v[128:131], v[176:179], v[64:67]
    ds_read_b64_tr_b16 v[152:153], v20 offset:8192
    v_mfma_f32_16x16x32_bf16 v[68:71], v[132:135], v[176:179], v[68:71]
    ds_read_b64_tr_b16 v[154:155], v20 offset:9216
    v_mfma_f32_16x16x32_bf16 v[72:75], v[136:139], v[176:179], v[72:75]
    ds_read_b64_tr_b16 v[156:157], v21 offset:8192
    v_mfma_f32_16x16x32_bf16 v[76:79], v[140:143], v[176:179], v[76:79]
    ds_read_b64_tr_b16 v[158:159], v21 offset:9216
    v_mfma_f32_16x16x32_bf16 v[80:83], v[112:115], v[180:183], v[80:83]
    ds_read_b64_tr_b16 v[160:161], v22 offset:8192
    v_mfma_f32_16x16x32_bf16 v[84:87], v[116:119], v[180:183], v[84:87]
    ds_read_b64_tr_b16 v[162:163], v22 offset:9216
    v_mfma_f32_16x16x32_bf16 v[88:91], v[120:123], v[180:183], v[88:91]
    ds_read_b64_tr_b16 v[164:165], v23 offset:8192
    v_mfma_f32_16x16x32_bf16 v[92:95], v[124:127], v[180:183], v[92:95]
    ds_read_b64_tr_b16 v[166:167], v23 offset:9216
    v_mfma_f32_16x16x32_bf16 v[96:99], v[128:131], v[180:183], v[96:99]
    ds_read_b64_tr_b16 v[168:169], v24 offset:8192
    v_mfma_f32_16x16x32_bf16 v[100:103], v[132:135], v[180:183], v[100:103]
    ds_read_b64_tr_b16 v[170:171], v24 offset:9216
    v_mfma_f32_16x16x32_bf16 v[104:107], v[136:139], v[180:183], v[104:107]
    ds_read_b64_tr_b16 v[172:173], v25 offset:8192
    v_mfma_f32_16x16x32_bf16 v[108:111], v[140:143], v[180:183], v[108:111]
    ds_read_b64_tr_b16 v[174:175], v25 offset:9216
    s_barrier
    v_add_u32 v16, 0x8000, v16
    v_add_u32 v17, 0x8000, v17
    v_add_u32 v18, 0x8000, v18
    v_add_u32 v19, 0x8000, v19
    v_add_u32 v20, 0x8000, v20
    v_add_u32 v21, 0x8000, v21
    v_add_u32 v22, 0x8000, v22
    v_add_u32 v23, 0x8000, v23
    v_add_u32 v24, 0x8000, v24
    v_add_u32 v25, 0x8000, v25
    s_waitcnt lgkmcnt(0)
    v_mfma_f32_16x16x32_bf16 v[48:51], v[144:147], v[184:187], v[48:51]
    ds_read_b128 v[176:179], v16 offset:0
    ds_read_b128 v[180:183], v16 offset:2048
    v_mfma_f32_16x16x32_bf16 v[52:55], v[148:151], v[184:187], v[52:55]
    ds_read_b64_tr_b16 v[112:113], v18 offset:0
    ds_read_b64_tr_b16 v[114:115], v18 offset:1024
    v_mfma_f32_16x16x32_bf16 v[56:59], v[152:155], v[184:187], v[56:59]
    ds_read_b64_tr_b16 v[116:117], v19 offset:0
    v_mfma_f32_16x16x32_bf16 v[60:63], v[156:159], v[184:187], v[60:63]
    ds_read_b64_tr_b16 v[118:119], v19 offset:1024
    v_mfma_f32_16x16x32_bf16 v[64:67], v[160:163], v[184:187], v[64:67]
    ds_read_b64_tr_b16 v[120:121], v20 offset:0
    v_mfma_f32_16x16x32_bf16 v[68:71], v[164:167], v[184:187], v[68:71]
    ds_read_b64_tr_b16 v[122:123], v20 offset:1024
    v_mfma_f32_16x16x32_bf16 v[72:75], v[168:171], v[184:187], v[72:75]
    ds_read_b64_tr_b16 v[124:125], v21 offset:0
    v_mfma_f32_16x16x32_bf16 v[76:79], v[172:175], v[184:187], v[76:79]
    ds_read_b64_tr_b16 v[126:127], v21 offset:1024
    v_mfma_f32_16x16x32_bf16 v[80:83], v[144:147], v[188:191], v[80:83]
    ds_read_b64_tr_b16 v[128:129], v22 offset:0
    v_mfma_f32_16x16x32_bf16 v[84:87], v[148:151], v[188:191], v[84:87]
    ds_read_b64_tr_b16 v[130:131], v22 offset:1024
    v_mfma_f32_16x16x32_bf16 v[88:91], v[152:155], v[188:191], v[88:91]
    ds_read_b64_tr_b16 v[132:133], v23 offset:0
    v_mfma_f32_16x16x32_bf16 v[92:95], v[156:159], v[188:191], v[92:95]
    ds_read_b64_tr_b16 v[134:135], v23 offset:1024
    v_mfma_f32_16x16x32_bf16 v[96:99], v[160:163], v[188:191], v[96:99]
    ds_read_b64_tr_b16 v[136:137], v24 offset:0
    v_mfma_f32_16x16x32_bf16 v[100:103], v[164:167], v[188:191], v[100:103]
    ds_read_b64_tr_b16 v[138:139], v24 offset:1024
    v_mfma_f32_16x16x32_bf16 v[104:107], v[168:171], v[188:191], v[104:107]
    ds_read_b64_tr_b16 v[140:141], v25 offset:0
    v_mfma_f32_16x16x32_bf16 v[108:111], v[172:175], v[188:191], v[108:111]
    ds_read_b64_tr_b16 v[142:143], v25 offset:1024
    s_waitcnt lgkmcnt(0)
    v_mfma_f32_16x16x32_bf16 v[48:51], v[112:115], v[176:179], v[48:51]
    ds_read_b128 v[184:187], v17 offset:0
    ds_read_b128 v[188:191], v17 offset:2048
    v_mfma_f32_16x16x32_bf16 v[52:55], v[116:119], v[176:179], v[52:55]
    ds_read_b64_tr_b16 v[144:145], v18 offset:8192
    ds_read_b64_tr_b16 v[146:147], v18 offset:9216
    v_mfma_f32_16x16x32_bf16 v[56:59], v[120:123], v[176:179], v[56:59]
    ds_read_b64_tr_b16 v[148:149], v19 offset:8192
    v_mfma_f32_16x16x32_bf16 v[60:63], v[124:127], v[176:179], v[60:63]
    ds_read_b64_tr_b16 v[150:151], v19 offset:9216
    v_mfma_f32_16x16x32_bf16 v[64:67], v[128:131], v[176:179], v[64:67]
    ds_read_b64_tr_b16 v[152:153], v20 offset:8192
    v_mfma_f32_16x16x32_bf16 v[68:71], v[132:135], v[176:179], v[68:71]
    ds_read_b64_tr_b16 v[154:155], v20 offset:9216
    v_mfma_f32_16x16x32_bf16 v[72:75], v[136:139], v[176:179], v[72:75]
    ds_read_b64_tr_b16 v[156:157], v21 offset:8192
    v_mfma_f32_16x16x32_bf16 v[76:79], v[140:143], v[176:179], v[76:79]
    ds_read_b64_tr_b16 v[158:159], v21 offset:9216
    v_mfma_f32_16x16x32_bf16 v[80:83], v[112:115], v[180:183], v[80:83]
    ds_read_b64_tr_b16 v[160:161], v22 offset:8192
    v_mfma_f32_16x16x32_bf16 v[84:87], v[116:119], v[180:183], v[84:87]
    ds_read_b64_tr_b16 v[162:163], v22 offset:9216
    v_mfma_f32_16x16x32_bf16 v[88:91], v[120:123], v[180:183], v[88:91]
    ds_read_b64_tr_b16 v[164:165], v23 offset:8192
    v_mfma_f32_16x16x32_bf16 v[92:95], v[124:127], v[180:183], v[92:95]
    ds_read_b64_tr_b16 v[166:167], v23 offset:9216
    v_mfma_f32_16x16x32_bf16 v[96:99], v[128:131], v[180:183], v[96:99]
    ds_read_b64_tr_b16 v[168:169], v24 offset:8192
    v_mfma_f32_16x16x32_bf16 v[100:103], v[132:135], v[180:183], v[100:103]
    ds_read_b64_tr_b16 v[170:171], v24 offset:9216
    v_mfma_f32_16x16x32_bf16 v[104:107], v[136:139], v[180:183], v[104:107]
    ds_read_b64_tr_b16 v[172:173], v25 offset:8192
    v_mfma_f32_16x16x32_bf16 v[108:111], v[140:143], v[180:183], v[108:111]
    ds_read_b64_tr_b16 v[174:175], v25 offset:9216
    s_barrier
    v_add_u32 v16, 0x8000, v16
    v_add_u32 v17, 0x8000, v17
    v_add_u32 v18, 0x8000, v18
    v_add_u32 v19, 0x8000, v19
    v_add_u32 v20, 0x8000, v20
    v_add_u32 v21, 0x8000, v21
    v_add_u32 v22, 0x8000, v22
    v_add_u32 v23, 0x8000, v23
    v_add_u32 v24, 0x8000, v24
    v_add_u32 v25, 0x8000, v25
    s_waitcnt lgkmcnt(0)
    v_mfma_f32_16x16x32_bf16 v[48:51], v[144:147], v[184:187], v[48:51]
    ds_read_b128 v[176:179], v16 offset:0
    ds_read_b128 v[180:183], v16 offset:2048
    v_mfma_f32_16x16x32_bf16 v[52:55], v[148:151], v[184:187], v[52:55]
    ds_read_b64_tr_b16 v[112:113], v18 offset:0
    ds_read_b64_tr_b16 v[114:115], v18 offset:1024
    v_mfma_f32_16x16x32_bf16 v[56:59], v[152:155], v[184:187], v[56:59]
    ds_read_b64_tr_b16 v[116:117], v19 offset:0
    v_mfma_f32_16x16x32_bf16 v[60:63], v[156:159], v[184:187], v[60:63]
    ds_read_b64_tr_b16 v[118:119], v19 offset:1024
    v_mfma_f32_16x16x32_bf16 v[64:67], v[160:163], v[184:187], v[64:67]
    ds_read_b64_tr_b16 v[120:121], v20 offset:0
    v_mfma_f32_16x16x32_bf16 v[68:71], v[164:167], v[184:187], v[68:71]
    ds_read_b64_tr_b16 v[122:123], v20 offset:1024
    v_mfma_f32_16x16x32_bf16 v[72:75], v[168:171], v[184:187], v[72:75]
    ds_read_b64_tr_b16 v[124:125], v21 offset:0
    v_mfma_f32_16x16x32_bf16 v[76:79], v[172:175], v[184:187], v[76:79]
    ds_read_b64_tr_b16 v[126:127], v21 offset:1024
    v_mfma_f32_16x16x32_bf16 v[80:83], v[144:147], v[188:191], v[80:83]
    ds_read_b64_tr_b16 v[128:129], v22 offset:0
    v_mfma_f32_16x16x32_bf16 v[84:87], v[148:151], v[188:191], v[84:87]
    ds_read_b64_tr_b16 v[130:131], v22 offset:1024
    v_mfma_f32_16x16x32_bf16 v[88:91], v[152:155], v[188:191], v[88:91]
    ds_read_b64_tr_b16 v[132:133], v23 offset:0
    v_mfma_f32_16x16x32_bf16 v[92:95], v[156:159], v[188:191], v[92:95]
    ds_read_b64_tr_b16 v[134:135], v23 offset:1024
    v_mfma_f32_16x16x32_bf16 v[96:99], v[160:163], v[188:191], v[96:99]
    ds_read_b64_tr_b16 v[136:137], v24 offset:0
    v_mfma_f32_16x16x32_bf16 v[100:103], v[164:167], v[188:191], v[100:103]
    ds_read_b64_tr_b16 v[138:139], v24 offset:1024
    v_mfma_f32_16x16x32_bf16 v[104:107], v[168:171], v[188:191], v[104:107]
    ds_read_b64_tr_b16 v[140:141], v25 offset:0
    v_mfma_f32_16x16x32_bf16 v[108:111], v[172:175], v[188:191], v[108:111]
    ds_read_b64_tr_b16 v[142:143], v25 offset:1024
    s_waitcnt lgkmcnt(0)
    v_mfma_f32_16x16x32_bf16 v[48:51], v[112:115], v[176:179], v[48:51]
    ds_read_b128 v[184:187], v17 offset:0
    ds_read_b128 v[188:191], v17 offset:2048
    v_mfma_f32_16x16x32_bf16 v[52:55], v[116:119], v[176:179], v[52:55]
    ds_read_b64_tr_b16 v[144:145], v18 offset:8192
    ds_read_b64_tr_b16 v[146:147], v18 offset:9216
    v_mfma_f32_16x16x32_bf16 v[56:59], v[120:123], v[176:179], v[56:59]
    ds_read_b64_tr_b16 v[148:149], v19 offset:8192
    v_mfma_f32_16x16x32_bf16 v[60:63], v[124:127], v[176:179], v[60:63]
    ds_read_b64_tr_b16 v[150:151], v19 offset:9216
    v_mfma_f32_16x16x32_bf16 v[64:67], v[128:131], v[176:179], v[64:67]
    ds_read_b64_tr_b16 v[152:153], v20 offset:8192
    v_mfma_f32_16x16x32_bf16 v[68:71], v[132:135], v[176:179], v[68:71]
    ds_read_b64_tr_b16 v[154:155], v20 offset:9216
    v_mfma_f32_16x16x32_bf16 v[72:75], v[136:139], v[176:179], v[72:75]
    ds_read_b64_tr_b16 v[156:157], v21 offset:8192
    v_mfma_f32_16x16x32_bf16 v[76:79], v[140:143], v[176:179], v[76:79]
    ds_read_b64_tr_b16 v[158:159], v21 offset:9216
    v_mfma_f32_16x16x32_bf16 v[80:83], v[112:115], v[180:183], v[80:83]
    ds_read_b64_tr_b16 v[160:161], v22 offset:8192
    v_mfma_f32_16x16x32_bf16 v[84:87], v[116:119], v[180:183], v[84:87]
    ds_read_b64_tr_b16 v[162:163], v22 offset:9216
    v_mfma_f32_16x16x32_bf16 v[88:91], v[120:123], v[180:183], v[88:91]
    ds_read_b64_tr_b16 v[164:165], v23 offset:8192
    v_mfma_f32_16x16x32_bf16 v[92:95], v[124:127], v[180:183], v[92:95]
    ds_read_b64_tr_b16 v[166:167], v23 offset:9216
    v_mfma_f32_16x16x32_bf16 v[96:99], v[128:131], v[180:183], v[96:99]
    ds_read_b64_tr_b16 v[168:169], v24 offset:8192
    v_mfma_f32_16x16x32_bf16 v[100:103], v[132:135], v[180:183], v[100:103]
    ds_read_b64_tr_b16 v[170:171], v24 offset:9216
    v_mfma_f32_16x16x32_bf16 v[104:107], v[136:139], v[180:183], v[104:107]
    ds_read_b64_tr_b16 v[172:173], v25 offset:8192
    v_mfma_f32_16x16x32_bf16 v[108:111], v[140:143], v[180:183], v[108:111]
    ds_read_b64_tr_b16 v[174:175], v25 offset:9216
    s_barrier
    v_add_u32 v16, 0xfffe0000, v16
    v_add_u32 v17, 0xfffe0000, v17
    v_add_u32 v18, 0xfffe0000, v18
    v_add_u32 v19, 0xfffe0000, v19
    v_add_u32 v20, 0xfffe0000, v20
    v_add_u32 v21, 0xfffe0000, v21
    v_add_u32 v22, 0xfffe0000, v22
    v_add_u32 v23, 0xfffe0000, v23
    v_add_u32 v24, 0xfffe0000, v24
    v_add_u32 v25, 0xfffe0000, v25
    s_waitcnt lgkmcnt(0)
    v_mfma_f32_16x16x32_bf16 v[48:51], v[144:147], v[184:187], v[48:51]
    ds_read_b128 v[176:179], v16 offset:0
    ds_read_b128 v[180:183], v16 offset:2048
    v_mfma_f32_16x16x32_bf16 v[52:55], v[148:151], v[184:187], v[52:55]
    ds_read_b64_tr_b16 v[112:113], v18 offset:0
    ds_read_b64_tr_b16 v[114:115], v18 offset:1024
    v_mfma_f32_16x16x32_bf16 v[56:59], v[152:155], v[184:187], v[56:59]
    ds_read_b64_tr_b16 v[116:117], v19 offset:0
    v_mfma_f32_16x16x32_bf16 v[60:63], v[156:159], v[184:187], v[60:63]
    ds_read_b64_tr_b16 v[118:119], v19 offset:1024
    v_mfma_f32_16x16x32_bf16 v[64:67], v[160:163], v[184:187], v[64:67]
    ds_read_b64_tr_b16 v[120:121], v20 offset:0
    v_mfma_f32_16x16x32_bf16 v[68:71], v[164:167], v[184:187], v[68:71]
    ds_read_b64_tr_b16 v[122:123], v20 offset:1024
    v_mfma_f32_16x16x32_bf16 v[72:75], v[168:171], v[184:187], v[72:75]
    ds_read_b64_tr_b16 v[124:125], v21 offset:0
    v_mfma_f32_16x16x32_bf16 v[76:79], v[172:175], v[184:187], v[76:79]
    ds_read_b64_tr_b16 v[126:127], v21 offset:1024
    v_mfma_f32_16x16x32_bf16 v[80:83], v[144:147], v[188:191], v[80:83]
    ds_read_b64_tr_b16 v[128:129], v22 offset:0
    v_mfma_f32_16x16x32_bf16 v[84:87], v[148:151], v[188:191], v[84:87]
    ds_read_b64_tr_b16 v[130:131], v22 offset:1024
    v_mfma_f32_16x16x32_bf16 v[88:91], v[152:155], v[188:191], v[88:91]
    ds_read_b64_tr_b16 v[132:133], v23 offset:0
    v_mfma_f32_16x16x32_bf16 v[92:95], v[156:159], v[188:191], v[92:95]
    ds_read_b64_tr_b16 v[134:135], v23 offset:1024
    v_mfma_f32_16x16x32_bf16 v[96:99], v[160:163], v[188:191], v[96:99]
    ds_read_b64_tr_b16 v[136:137], v24 offset:0
    v_mfma_f32_16x16x32_bf16 v[100:103], v[164:167], v[188:191], v[100:103]
    ds_read_b64_tr_b16 v[138:139], v24 offset:1024
    v_mfma_f32_16x16x32_bf16 v[104:107], v[168:171], v[188:191], v[104:107]
    ds_read_b64_tr_b16 v[140:141], v25 offset:0
    v_mfma_f32_16x16x32_bf16 v[108:111], v[172:175], v[188:191], v[108:111]
    ds_read_b64_tr_b16 v[142:143], v25 offset:1024
    s_waitcnt lgkmcnt(0)
    v_mfma_f32_16x16x32_bf16 v[48:51], v[112:115], v[176:179], v[48:51]
    ds_read_b128 v[184:187], v17 offset:0
    ds_read_b128 v[188:191], v17 offset:2048
    v_mfma_f32_16x16x32_bf16 v[52:55], v[116:119], v[176:179], v[52:55]
    ds_read_b64_tr_b16 v[144:145], v18 offset:8192
    ds_read_b64_tr_b16 v[146:147], v18 offset:9216
    v_mfma_f32_16x16x32_bf16 v[56:59], v[120:123], v[176:179], v[56:59]
    ds_read_b64_tr_b16 v[148:149], v19 offset:8192
    v_mfma_f32_16x16x32_bf16 v[60:63], v[124:127], v[176:179], v[60:63]
    ds_read_b64_tr_b16 v[150:151], v19 offset:9216
    v_mfma_f32_16x16x32_bf16 v[64:67], v[128:131], v[176:179], v[64:67]
    ds_read_b64_tr_b16 v[152:153], v20 offset:8192
    v_mfma_f32_16x16x32_bf16 v[68:71], v[132:135], v[176:179], v[68:71]
    ds_read_b64_tr_b16 v[154:155], v20 offset:9216
    v_mfma_f32_16x16x32_bf16 v[72:75], v[136:139], v[176:179], v[72:75]
    ds_read_b64_tr_b16 v[156:157], v21 offset:8192
    v_mfma_f32_16x16x32_bf16 v[76:79], v[140:143], v[176:179], v[76:79]
    ds_read_b64_tr_b16 v[158:159], v21 offset:9216
    v_mfma_f32_16x16x32_bf16 v[80:83], v[112:115], v[180:183], v[80:83]
    ds_read_b64_tr_b16 v[160:161], v22 offset:8192
    v_mfma_f32_16x16x32_bf16 v[84:87], v[116:119], v[180:183], v[84:87]
    ds_read_b64_tr_b16 v[162:163], v22 offset:9216
    v_mfma_f32_16x16x32_bf16 v[88:91], v[120:123], v[180:183], v[88:91]
    ds_read_b64_tr_b16 v[164:165], v23 offset:8192
    v_mfma_f32_16x16x32_bf16 v[92:95], v[124:127], v[180:183], v[92:95]
    ds_read_b64_tr_b16 v[166:167], v23 offset:9216
    v_mfma_f32_16x16x32_bf16 v[96:99], v[128:131], v[180:183], v[96:99]
    ds_read_b64_tr_b16 v[168:169], v24 offset:8192
    v_mfma_f32_16x16x32_bf16 v[100:103], v[132:135], v[180:183], v[100:103]
    ds_read_b64_tr_b16 v[170:171], v24 offset:9216
    v_mfma_f32_16x16x32_bf16 v[104:107], v[136:139], v[180:183], v[104:107]
    ds_read_b64_tr_b16 v[172:173], v25 offset:8192
    v_mfma_f32_16x16x32_bf16 v[108:111], v[140:143], v[180:183], v[108:111]
    ds_read_b64_tr_b16 v[174:175], v25 offset:9216
    s_barrier
    v_add_u32 v16, 0x8000, v16
    v_add_u32 v17, 0x8000, v17
    v_add_u32 v18, 0x8000, v18
    v_add_u32 v19, 0x8000, v19
    v_add_u32 v20, 0x8000, v20
    v_add_u32 v21, 0x8000, v21
    v_add_u32 v22, 0x8000, v22
    v_add_u32 v23, 0x8000, v23
    v_add_u32 v24, 0x8000, v24
    v_add_u32 v25, 0x8000, v25
    s_waitcnt lgkmcnt(0)
    v_mfma_f32_16x16x32_bf16 v[48:51], v[144:147], v[184:187], v[48:51]
    ds_read_b128 v[176:179], v16 offset:0
    ds_read_b128 v[180:183], v16 offset:2048
    v_mfma_f32_16x16x32_bf16 v[52:55], v[148:151], v[184:187], v[52:55]
    ds_read_b64_tr_b16 v[112:113], v18 offset:0
    ds_read_b64_tr_b16 v[114:115], v18 offset:1024
    v_mfma_f32_16x16x32_bf16 v[56:59], v[152:155], v[184:187], v[56:59]
    ds_read_b64_tr_b16 v[116:117], v19 offset:0
    v_mfma_f32_16x16x32_bf16 v[60:63], v[156:159], v[184:187], v[60:63]
    ds_read_b64_tr_b16 v[118:119], v19 offset:1024
    v_mfma_f32_16x16x32_bf16 v[64:67], v[160:163], v[184:187], v[64:67]
    ds_read_b64_tr_b16 v[120:121], v20 offset:0
    v_mfma_f32_16x16x32_bf16 v[68:71], v[164:167], v[184:187], v[68:71]
    ds_read_b64_tr_b16 v[122:123], v20 offset:1024
    v_mfma_f32_16x16x32_bf16 v[72:75], v[168:171], v[184:187], v[72:75]
    ds_read_b64_tr_b16 v[124:125], v21 offset:0
    v_mfma_f32_16x16x32_bf16 v[76:79], v[172:175], v[184:187], v[76:79]
    ds_read_b64_tr_b16 v[126:127], v21 offset:1024
    v_mfma_f32_16x16x32_bf16 v[80:83], v[144:147], v[188:191], v[80:83]
    ds_read_b64_tr_b16 v[128:129], v22 offset:0
    v_mfma_f32_16x16x32_bf16 v[84:87], v[148:151], v[188:191], v[84:87]
    ds_read_b64_tr_b16 v[130:131], v22 offset:1024
    v_mfma_f32_16x16x32_bf16 v[88:91], v[152:155], v[188:191], v[88:91]
    ds_read_b64_tr_b16 v[132:133], v23 offset:0
    v_mfma_f32_16x16x32_bf16 v[92:95], v[156:159], v[188:191], v[92:95]
    ds_read_b64_tr_b16 v[134:135], v23 offset:1024
    v_mfma_f32_16x16x32_bf16 v[96:99], v[160:163], v[188:191], v[96:99]
    ds_read_b64_tr_b16 v[136:137], v24 offset:0
    v_mfma_f32_16x16x32_bf16 v[100:103], v[164:167], v[188:191], v[100:103]
    ds_read_b64_tr_b16 v[138:139], v24 offset:1024
    v_mfma_f32_16x16x32_bf16 v[104:107], v[168:171], v[188:191], v[104:107]
    ds_read_b64_tr_b16 v[140:141], v25 offset:0
    v_mfma_f32_16x16x32_bf16 v[108:111], v[172:175], v[188:191], v[108:111]
    ds_read_b64_tr_b16 v[142:143], v25 offset:1024
    s_waitcnt lgkmcnt(0)
    v_mfma_f32_16x16x32_bf16 v[48:51], v[112:115], v[176:179], v[48:51]
    ds_read_b128 v[184:187], v17 offset:0
    ds_read_b128 v[188:191], v17 offset:2048
    v_mfma_f32_16x16x32_bf16 v[52:55], v[116:119], v[176:179], v[52:55]
    ds_read_b64_tr_b16 v[144:145], v18 offset:8192
    ds_read_b64_tr_b16 v[146:147], v18 offset:9216
    v_mfma_f32_16x16x32_bf16 v[56:59], v[120:123], v[176:179], v[56:59]
    ds_read_b64_tr_b16 v[148:149], v19 offset:8192
    v_mfma_f32_16x16x32_bf16 v[60:63], v[124:127], v[176:179], v[60:63]
    ds_read_b64_tr_b16 v[150:151], v19 offset:9216
    v_mfma_f32_16x16x32_bf16 v[64:67], v[128:131], v[176:179], v[64:67]
    ds_read_b64_tr_b16 v[152:153], v20 offset:8192
    v_mfma_f32_16x16x32_bf16 v[68:71], v[132:135], v[176:179], v[68:71]
    ds_read_b64_tr_b16 v[154:155], v20 offset:9216
    v_mfma_f32_16x16x32_bf16 v[72:75], v[136:139], v[176:179], v[72:75]
    ds_read_b64_tr_b16 v[156:157], v21 offset:8192
    v_mfma_f32_16x16x32_bf16 v[76:79], v[140:143], v[176:179], v[76:79]
    ds_read_b64_tr_b16 v[158:159], v21 offset:9216
    v_mfma_f32_16x16x32_bf16 v[80:83], v[112:115], v[180:183], v[80:83]
    ds_read_b64_tr_b16 v[160:161], v22 offset:8192
    v_mfma_f32_16x16x32_bf16 v[84:87], v[116:119], v[180:183], v[84:87]
    ds_read_b64_tr_b16 v[162:163], v22 offset:9216
    v_mfma_f32_16x16x32_bf16 v[88:91], v[120:123], v[180:183], v[88:91]
    ds_read_b64_tr_b16 v[164:165], v23 offset:8192
    v_mfma_f32_16x16x32_bf16 v[92:95], v[124:127], v[180:183], v[92:95]
    ds_read_b64_tr_b16 v[166:167], v23 offset:9216
    v_mfma_f32_16x16x32_bf16 v[96:99], v[128:131], v[180:183], v[96:99]
    ds_read_b64_tr_b16 v[168:169], v24 offset:8192
    v_mfma_f32_16x16x32_bf16 v[100:103], v[132:135], v[180:183], v[100:103]
    ds_read_b64_tr_b16 v[170:171], v24 offset:9216
    v_mfma_f32_16x16x32_bf16 v[104:107], v[136:139], v[180:183], v[104:107]
    ds_read_b64_tr_b16 v[172:173], v25 offset:8192
    v_mfma_f32_16x16x32_bf16 v[108:111], v[140:143], v[180:183], v[108:111]
    ds_read_b64_tr_b16 v[174:175], v25 offset:9216
    s_barrier
    v_add_u32 v16, 0x8000, v16
    v_add_u32 v17, 0x8000, v17
    v_add_u32 v18, 0x8000, v18
    v_add_u32 v19, 0x8000, v19
    v_add_u32 v20, 0x8000, v20
    v_add_u32 v21, 0x8000, v21
    v_add_u32 v22, 0x8000, v22
    v_add_u32 v23, 0x8000, v23
    v_add_u32 v24, 0x8000, v24
    v_add_u32 v25, 0x8000, v25
    s_waitcnt lgkmcnt(0)
    v_mfma_f32_16x16x32_bf16 v[48:51], v[144:147], v[184:187], v[48:51]
    ds_read_b128 v[176:179], v16 offset:0
    ds_read_b128 v[180:183], v16 offset:2048
    v_mfma_f32_16x16x32_bf16 v[52:55], v[148:151], v[184:187], v[52:55]
    ds_read_b64_tr_b16 v[112:113], v18 offset:0
    ds_read_b64_tr_b16 v[114:115], v18 offset:1024
    v_mfma_f32_16x16x32_bf16 v[56:59], v[152:155], v[184:187], v[56:59]
    ds_read_b64_tr_b16 v[116:117], v19 offset:0
    v_mfma_f32_16x16x32_bf16 v[60:63], v[156:159], v[184:187], v[60:63]
    ds_read_b64_tr_b16 v[118:119], v19 offset:1024
    v_mfma_f32_16x16x32_bf16 v[64:67], v[160:163], v[184:187], v[64:67]
    ds_read_b64_tr_b16 v[120:121], v20 offset:0
    v_mfma_f32_16x16x32_bf16 v[68:71], v[164:167], v[184:187], v[68:71]
    ds_read_b64_tr_b16 v[122:123], v20 offset:1024
    v_mfma_f32_16x16x32_bf16 v[72:75], v[168:171], v[184:187], v[72:75]
    ds_read_b64_tr_b16 v[124:125], v21 offset:0
    v_mfma_f32_16x16x32_bf16 v[76:79], v[172:175], v[184:187], v[76:79]
    ds_read_b64_tr_b16 v[126:127], v21 offset:1024
    v_mfma_f32_16x16x32_bf16 v[80:83], v[144:147], v[188:191], v[80:83]
    ds_read_b64_tr_b16 v[128:129], v22 offset:0
    v_mfma_f32_16x16x32_bf16 v[84:87], v[148:151], v[188:191], v[84:87]
    ds_read_b64_tr_b16 v[130:131], v22 offset:1024
    v_mfma_f32_16x16x32_bf16 v[88:91], v[152:155], v[188:191], v[88:91]
    ds_read_b64_tr_b16 v[132:133], v23 offset:0
    v_mfma_f32_16x16x32_bf16 v[92:95], v[156:159], v[188:191], v[92:95]
    ds_read_b64_tr_b16 v[134:135], v23 offset:1024
    v_mfma_f32_16x16x32_bf16 v[96:99], v[160:163], v[188:191], v[96:99]
    ds_read_b64_tr_b16 v[136:137], v24 offset:0
    v_mfma_f32_16x16x32_bf16 v[100:103], v[164:167], v[188:191], v[100:103]
    ds_read_b64_tr_b16 v[138:139], v24 offset:1024
    v_mfma_f32_16x16x32_bf16 v[104:107], v[168:171], v[188:191], v[104:107]
    ds_read_b64_tr_b16 v[140:141], v25 offset:0
    v_mfma_f32_16x16x32_bf16 v[108:111], v[172:175], v[188:191], v[108:111]
    ds_read_b64_tr_b16 v[142:143], v25 offset:1024
    s_waitcnt lgkmcnt(0)
    v_mfma_f32_16x16x32_bf16 v[48:51], v[112:115], v[176:179], v[48:51]
    ds_read_b128 v[184:187], v17 offset:0
    ds_read_b128 v[188:191], v17 offset:2048
    v_mfma_f32_16x16x32_bf16 v[52:55], v[116:119], v[176:179], v[52:55]
    ds_read_b64_tr_b16 v[144:145], v18 offset:8192
    ds_read_b64_tr_b16 v[146:147], v18 offset:9216
    v_mfma_f32_16x16x32_bf16 v[56:59], v[120:123], v[176:179], v[56:59]
    ds_read_b64_tr_b16 v[148:149], v19 offset:8192
    v_mfma_f32_16x16x32_bf16 v[60:63], v[124:127], v[176:179], v[60:63]
    ds_read_b64_tr_b16 v[150:151], v19 offset:9216
    v_mfma_f32_16x16x32_bf16 v[64:67], v[128:131], v[176:179], v[64:67]
    ds_read_b64_tr_b16 v[152:153], v20 offset:8192
    v_mfma_f32_16x16x32_bf16 v[68:71], v[132:135], v[176:179], v[68:71]
    ds_read_b64_tr_b16 v[154:155], v20 offset:9216
    v_mfma_f32_16x16x32_bf16 v[72:75], v[136:139], v[176:179], v[72:75]
    ds_read_b64_tr_b16 v[156:157], v21 offset:8192
    v_mfma_f32_16x16x32_bf16 v[76:79], v[140:143], v[176:179], v[76:79]
    ds_read_b64_tr_b16 v[158:159], v21 offset:9216
    v_mfma_f32_16x16x32_bf16 v[80:83], v[112:115], v[180:183], v[80:83]
    ds_read_b64_tr_b16 v[160:161], v22 offset:8192
    v_mfma_f32_16x16x32_bf16 v[84:87], v[116:119], v[180:183], v[84:87]
    ds_read_b64_tr_b16 v[162:163], v22 offset:9216
    v_mfma_f32_16x16x32_bf16 v[88:91], v[120:123], v[180:183], v[88:91]
    ds_read_b64_tr_b16 v[164:165], v23 offset:8192
    v_mfma_f32_16x16x32_bf16 v[92:95], v[124:127], v[180:183], v[92:95]
    ds_read_b64_tr_b16 v[166:167], v23 offset:9216
    v_mfma_f32_16x16x32_bf16 v[96:99], v[128:131], v[180:183], v[96:99]
    ds_read_b64_tr_b16 v[168:169], v24 offset:8192
    v_mfma_f32_16x16x32_bf16 v[100:103], v[132:135], v[180:183], v[100:103]
    ds_read_b64_tr_b16 v[170:171], v24 offset:9216
    v_mfma_f32_16x16x32_bf16 v[104:107], v[136:139], v[180:183], v[104:107]
    ds_read_b64_tr_b16 v[172:173], v25 offset:8192
    v_mfma_f32_16x16x32_bf16 v[108:111], v[140:143], v[180:183], v[108:111]
    ds_read_b64_tr_b16 v[174:175], v25 offset:9216
    s_barrier
    v_add_u32 v16, 0x8000, v16
    v_add_u32 v17, 0x8000, v17
    v_add_u32 v18, 0x8000, v18
    v_add_u32 v19, 0x8000, v19
    v_add_u32 v20, 0x8000, v20
    v_add_u32 v21, 0x8000, v21
    v_add_u32 v22, 0x8000, v22
    v_add_u32 v23, 0x8000, v23
    v_add_u32 v24, 0x8000, v24
    v_add_u32 v25, 0x8000, v25
    s_waitcnt lgkmcnt(0)
    v_mfma_f32_16x16x32_bf16 v[48:51], v[144:147], v[184:187], v[48:51]
    ds_read_b128 v[176:179], v16 offset:0
    ds_read_b128 v[180:183], v16 offset:2048
    v_mfma_f32_16x16x32_bf16 v[52:55], v[148:151], v[184:187], v[52:55]
    ds_read_b64_tr_b16 v[112:113], v18 offset:0
    ds_read_b64_tr_b16 v[114:115], v18 offset:1024
    v_mfma_f32_16x16x32_bf16 v[56:59], v[152:155], v[184:187], v[56:59]
    ds_read_b64_tr_b16 v[116:117], v19 offset:0
    v_mfma_f32_16x16x32_bf16 v[60:63], v[156:159], v[184:187], v[60:63]
    ds_read_b64_tr_b16 v[118:119], v19 offset:1024
    v_mfma_f32_16x16x32_bf16 v[64:67], v[160:163], v[184:187], v[64:67]
    ds_read_b64_tr_b16 v[120:121], v20 offset:0
    v_mfma_f32_16x16x32_bf16 v[68:71], v[164:167], v[184:187], v[68:71]
    ds_read_b64_tr_b16 v[122:123], v20 offset:1024
    v_mfma_f32_16x16x32_bf16 v[72:75], v[168:171], v[184:187], v[72:75]
    ds_read_b64_tr_b16 v[124:125], v21 offset:0
    v_mfma_f32_16x16x32_bf16 v[76:79], v[172:175], v[184:187], v[76:79]
    ds_read_b64_tr_b16 v[126:127], v21 offset:1024
    v_mfma_f32_16x16x32_bf16 v[80:83], v[144:147], v[188:191], v[80:83]
    ds_read_b64_tr_b16 v[128:129], v22 offset:0
    v_mfma_f32_16x16x32_bf16 v[84:87], v[148:151], v[188:191], v[84:87]
    ds_read_b64_tr_b16 v[130:131], v22 offset:1024
    v_mfma_f32_16x16x32_bf16 v[88:91], v[152:155], v[188:191], v[88:91]
    ds_read_b64_tr_b16 v[132:133], v23 offset:0
    v_mfma_f32_16x16x32_bf16 v[92:95], v[156:159], v[188:191], v[92:95]
    ds_read_b64_tr_b16 v[134:135], v23 offset:1024
    v_mfma_f32_16x16x32_bf16 v[96:99], v[160:163], v[188:191], v[96:99]
    ds_read_b64_tr_b16 v[136:137], v24 offset:0
    v_mfma_f32_16x16x32_bf16 v[100:103], v[164:167], v[188:191], v[100:103]
    ds_read_b64_tr_b16 v[138:139], v24 offset:1024
    v_mfma_f32_16x16x32_bf16 v[104:107], v[168:171], v[188:191], v[104:107]
    ds_read_b64_tr_b16 v[140:141], v25 offset:0
    v_mfma_f32_16x16x32_bf16 v[108:111], v[172:175], v[188:191], v[108:111]
    ds_read_b64_tr_b16 v[142:143], v25 offset:1024
    s_waitcnt lgkmcnt(0)
    v_mfma_f32_16x16x32_bf16 v[48:51], v[112:115], v[176:179], v[48:51]
    ds_read_b128 v[184:187], v17 offset:0
    ds_read_b128 v[188:191], v17 offset:2048
    v_mfma_f32_16x16x32_bf16 v[52:55], v[116:119], v[176:179], v[52:55]
    ds_read_b64_tr_b16 v[144:145], v18 offset:8192
    ds_read_b64_tr_b16 v[146:147], v18 offset:9216
    v_mfma_f32_16x16x32_bf16 v[56:59], v[120:123], v[176:179], v[56:59]
    ds_read_b64_tr_b16 v[148:149], v19 offset:8192
    v_mfma_f32_16x16x32_bf16 v[60:63], v[124:127], v[176:179], v[60:63]
    ds_read_b64_tr_b16 v[150:151], v19 offset:9216
    v_mfma_f32_16x16x32_bf16 v[64:67], v[128:131], v[176:179], v[64:67]
    ds_read_b64_tr_b16 v[152:153], v20 offset:8192
    v_mfma_f32_16x16x32_bf16 v[68:71], v[132:135], v[176:179], v[68:71]
    ds_read_b64_tr_b16 v[154:155], v20 offset:9216
    v_mfma_f32_16x16x32_bf16 v[72:75], v[136:139], v[176:179], v[72:75]
    ds_read_b64_tr_b16 v[156:157], v21 offset:8192
    v_mfma_f32_16x16x32_bf16 v[76:79], v[140:143], v[176:179], v[76:79]
    ds_read_b64_tr_b16 v[158:159], v21 offset:9216
    v_mfma_f32_16x16x32_bf16 v[80:83], v[112:115], v[180:183], v[80:83]
    ds_read_b64_tr_b16 v[160:161], v22 offset:8192
    v_mfma_f32_16x16x32_bf16 v[84:87], v[116:119], v[180:183], v[84:87]
    ds_read_b64_tr_b16 v[162:163], v22 offset:9216
    v_mfma_f32_16x16x32_bf16 v[88:91], v[120:123], v[180:183], v[88:91]
    ds_read_b64_tr_b16 v[164:165], v23 offset:8192
    v_mfma_f32_16x16x32_bf16 v[92:95], v[124:127], v[180:183], v[92:95]
    ds_read_b64_tr_b16 v[166:167], v23 offset:9216
    v_mfma_f32_16x16x32_bf16 v[96:99], v[128:131], v[180:183], v[96:99]
    ds_read_b64_tr_b16 v[168:169], v24 offset:8192
    v_mfma_f32_16x16x32_bf16 v[100:103], v[132:135], v[180:183], v[100:103]
    ds_read_b64_tr_b16 v[170:171], v24 offset:9216
    v_mfma_f32_16x16x32_bf16 v[104:107], v[136:139], v[180:183], v[104:107]
    ds_read_b64_tr_b16 v[172:173], v25 offset:8192
    v_mfma_f32_16x16x32_bf16 v[108:111], v[140:143], v[180:183], v[108:111]
    ds_read_b64_tr_b16 v[174:175], v25 offset:9216
    s_barrier
    v_add_u32 v16, 0x8000, v16
    v_add_u32 v17, 0x8000, v17
    v_add_u32 v18, 0x8000, v18
    v_add_u32 v19, 0x8000, v19
    v_add_u32 v20, 0x8000, v20
    v_add_u32 v21, 0x8000, v21
    v_add_u32 v22, 0x8000, v22
    v_add_u32 v23, 0x8000, v23
    v_add_u32 v24, 0x8000, v24
    v_add_u32 v25, 0x8000, v25
    s_waitcnt lgkmcnt(0)
    v_mfma_f32_16x16x32_bf16 v[48:51], v[144:147], v[184:187], v[48:51]
    ds_read_b128 v[176:179], v16 offset:0
    ds_read_b128 v[180:183], v16 offset:2048
    v_mfma_f32_16x16x32_bf16 v[52:55], v[148:151], v[184:187], v[52:55]
    ds_read_b64_tr_b16 v[112:113], v18 offset:0
    ds_read_b64_tr_b16 v[114:115], v18 offset:1024
    v_mfma_f32_16x16x32_bf16 v[56:59], v[152:155], v[184:187], v[56:59]
    ds_read_b64_tr_b16 v[116:117], v19 offset:0
    v_mfma_f32_16x16x32_bf16 v[60:63], v[156:159], v[184:187], v[60:63]
    ds_read_b64_tr_b16 v[118:119], v19 offset:1024
    v_mfma_f32_16x16x32_bf16 v[64:67], v[160:163], v[184:187], v[64:67]
    ds_read_b64_tr_b16 v[120:121], v20 offset:0
    v_mfma_f32_16x16x32_bf16 v[68:71], v[164:167], v[184:187], v[68:71]
    ds_read_b64_tr_b16 v[122:123], v20 offset:1024
    v_mfma_f32_16x16x32_bf16 v[72:75], v[168:171], v[184:187], v[72:75]
    ds_read_b64_tr_b16 v[124:125], v21 offset:0
    v_mfma_f32_16x16x32_bf16 v[76:79], v[172:175], v[184:187], v[76:79]
    ds_read_b64_tr_b16 v[126:127], v21 offset:1024
    v_mfma_f32_16x16x32_bf16 v[80:83], v[144:147], v[188:191], v[80:83]
    ds_read_b64_tr_b16 v[128:129], v22 offset:0
    v_mfma_f32_16x16x32_bf16 v[84:87], v[148:151], v[188:191], v[84:87]
    ds_read_b64_tr_b16 v[130:131], v22 offset:1024
    v_mfma_f32_16x16x32_bf16 v[88:91], v[152:155], v[188:191], v[88:91]
    ds_read_b64_tr_b16 v[132:133], v23 offset:0
    v_mfma_f32_16x16x32_bf16 v[92:95], v[156:159], v[188:191], v[92:95]
    ds_read_b64_tr_b16 v[134:135], v23 offset:1024
    v_mfma_f32_16x16x32_bf16 v[96:99], v[160:163], v[188:191], v[96:99]
    ds_read_b64_tr_b16 v[136:137], v24 offset:0
    v_mfma_f32_16x16x32_bf16 v[100:103], v[164:167], v[188:191], v[100:103]
    ds_read_b64_tr_b16 v[138:139], v24 offset:1024
    v_mfma_f32_16x16x32_bf16 v[104:107], v[168:171], v[188:191], v[104:107]
    ds_read_b64_tr_b16 v[140:141], v25 offset:0
    v_mfma_f32_16x16x32_bf16 v[108:111], v[172:175], v[188:191], v[108:111]
    ds_read_b64_tr_b16 v[142:143], v25 offset:1024
    s_waitcnt lgkmcnt(0)
    v_mfma_f32_16x16x32_bf16 v[48:51], v[112:115], v[176:179], v[48:51]
    ds_read_b128 v[184:187], v17 offset:0
    ds_read_b128 v[188:191], v17 offset:2048
    v_mfma_f32_16x16x32_bf16 v[52:55], v[116:119], v[176:179], v[52:55]
    ds_read_b64_tr_b16 v[144:145], v18 offset:8192
    ds_read_b64_tr_b16 v[146:147], v18 offset:9216
    v_mfma_f32_16x16x32_bf16 v[56:59], v[120:123], v[176:179], v[56:59]
    ds_read_b64_tr_b16 v[148:149], v19 offset:8192
    v_mfma_f32_16x16x32_bf16 v[60:63], v[124:127], v[176:179], v[60:63]
    ds_read_b64_tr_b16 v[150:151], v19 offset:9216
    v_mfma_f32_16x16x32_bf16 v[64:67], v[128:131], v[176:179], v[64:67]
    ds_read_b64_tr_b16 v[152:153], v20 offset:8192
    v_mfma_f32_16x16x32_bf16 v[68:71], v[132:135], v[176:179], v[68:71]
    ds_read_b64_tr_b16 v[154:155], v20 offset:9216
    v_mfma_f32_16x16x32_bf16 v[72:75], v[136:139], v[176:179], v[72:75]
    ds_read_b64_tr_b16 v[156:157], v21 offset:8192
    v_mfma_f32_16x16x32_bf16 v[76:79], v[140:143], v[176:179], v[76:79]
    ds_read_b64_tr_b16 v[158:159], v21 offset:9216
    v_mfma_f32_16x16x32_bf16 v[80:83], v[112:115], v[180:183], v[80:83]
    ds_read_b64_tr_b16 v[160:161], v22 offset:8192
    v_mfma_f32_16x16x32_bf16 v[84:87], v[116:119], v[180:183], v[84:87]
    ds_read_b64_tr_b16 v[162:163], v22 offset:9216
    v_mfma_f32_16x16x32_bf16 v[88:91], v[120:123], v[180:183], v[88:91]
    ds_read_b64_tr_b16 v[164:165], v23 offset:8192
    v_mfma_f32_16x16x32_bf16 v[92:95], v[124:127], v[180:183], v[92:95]
    ds_read_b64_tr_b16 v[166:167], v23 offset:9216
    v_mfma_f32_16x16x32_bf16 v[96:99], v[128:131], v[180:183], v[96:99]
    ds_read_b64_tr_b16 v[168:169], v24 offset:8192
    v_mfma_f32_16x16x32_bf16 v[100:103], v[132:135], v[180:183], v[100:103]
    ds_read_b64_tr_b16 v[170:171], v24 offset:9216
    v_mfma_f32_16x16x32_bf16 v[104:107], v[136:139], v[180:183], v[104:107]
    ds_read_b64_tr_b16 v[172:173], v25 offset:8192
    v_mfma_f32_16x16x32_bf16 v[108:111], v[140:143], v[180:183], v[108:111]
    ds_read_b64_tr_b16 v[174:175], v25 offset:9216
    s_waitcnt lgkmcnt(0)
    v_mfma_f32_16x16x32_bf16 v[48:51], v[144:147], v[184:187], v[48:51]
    v_mfma_f32_16x16x32_bf16 v[52:55], v[148:151], v[184:187], v[52:55]
    v_mfma_f32_16x16x32_bf16 v[56:59], v[152:155], v[184:187], v[56:59]
    v_mfma_f32_16x16x32_bf16 v[60:63], v[156:159], v[184:187], v[60:63]
    v_mfma_f32_16x16x32_bf16 v[64:67], v[160:163], v[184:187], v[64:67]
    v_mfma_f32_16x16x32_bf16 v[68:71], v[164:167], v[184:187], v[68:71]
    v_mfma_f32_16x16x32_bf16 v[72:75], v[168:171], v[184:187], v[72:75]
    v_mfma_f32_16x16x32_bf16 v[76:79], v[172:175], v[184:187], v[76:79]
    v_mfma_f32_16x16x32_bf16 v[80:83], v[144:147], v[188:191], v[80:83]
    v_mfma_f32_16x16x32_bf16 v[84:87], v[148:151], v[188:191], v[84:87]
    v_mfma_f32_16x16x32_bf16 v[88:91], v[152:155], v[188:191], v[88:91]
    v_mfma_f32_16x16x32_bf16 v[92:95], v[156:159], v[188:191], v[92:95]
    v_mfma_f32_16x16x32_bf16 v[96:99], v[160:163], v[188:191], v[96:99]
    v_mfma_f32_16x16x32_bf16 v[100:103], v[164:167], v[188:191], v[100:103]
    v_mfma_f32_16x16x32_bf16 v[104:107], v[168:171], v[188:191], v[104:107]
    v_mfma_f32_16x16x32_bf16 v[108:111], v[172:175], v[188:191], v[108:111]
    s_barrier
    s_nop 7
    v_max_f32 v48, 0, v48
    v_max_f32 v49, 0, v49
    v_max_f32 v50, 0, v50
    v_max_f32 v51, 0, v51
    v_pk_mul_f32 v[48:49], v[48:49], v[48:49]
    v_pk_mul_f32 v[50:51], v[50:51], v[50:51]
    v_cvt_pk_bf16_f32 v48, v48, v49
    v_cvt_pk_bf16_f32 v49, v50, v51
    ds_write_b64 v26, v[48:49] offset:0
    v_max_f32 v80, 0, v80
    v_max_f32 v81, 0, v81
    v_max_f32 v82, 0, v82
    v_max_f32 v83, 0, v83
    v_pk_mul_f32 v[80:81], v[80:81], v[80:81]
    v_pk_mul_f32 v[82:83], v[82:83], v[82:83]
    v_cvt_pk_bf16_f32 v80, v80, v81
    v_cvt_pk_bf16_f32 v81, v82, v83
    ds_write_b64 v26, v[80:81] offset:4352
    v_max_f32 v52, 0, v52
    v_max_f32 v53, 0, v53
    v_max_f32 v54, 0, v54
    v_max_f32 v55, 0, v55
    v_pk_mul_f32 v[52:53], v[52:53], v[52:53]
    v_pk_mul_f32 v[54:55], v[54:55], v[54:55]
    v_cvt_pk_bf16_f32 v52, v52, v53
    v_cvt_pk_bf16_f32 v53, v54, v55
    ds_write_b64 v26, v[52:53] offset:32
    v_max_f32 v84, 0, v84
    v_max_f32 v85, 0, v85
    v_max_f32 v86, 0, v86
    v_max_f32 v87, 0, v87
    v_pk_mul_f32 v[84:85], v[84:85], v[84:85]
    v_pk_mul_f32 v[86:87], v[86:87], v[86:87]
    v_cvt_pk_bf16_f32 v84, v84, v85
    v_cvt_pk_bf16_f32 v85, v86, v87
    ds_write_b64 v26, v[84:85] offset:4384
    v_max_f32 v56, 0, v56
    v_max_f32 v57, 0, v57
    v_max_f32 v58, 0, v58
    v_max_f32 v59, 0, v59
    v_pk_mul_f32 v[56:57], v[56:57], v[56:57]
    v_pk_mul_f32 v[58:59], v[58:59], v[58:59]
    v_cvt_pk_bf16_f32 v56, v56, v57
    v_cvt_pk_bf16_f32 v57, v58, v59
    ds_write_b64 v26, v[56:57] offset:64
    v_max_f32 v88, 0, v88
    v_max_f32 v89, 0, v89
    v_max_f32 v90, 0, v90
    v_max_f32 v91, 0, v91
    v_pk_mul_f32 v[88:89], v[88:89], v[88:89]
    v_pk_mul_f32 v[90:91], v[90:91], v[90:91]
    v_cvt_pk_bf16_f32 v88, v88, v89
    v_cvt_pk_bf16_f32 v89, v90, v91
    ds_write_b64 v26, v[88:89] offset:4416
    v_max_f32 v60, 0, v60
    v_max_f32 v61, 0, v61
    v_max_f32 v62, 0, v62
    v_max_f32 v63, 0, v63
    v_pk_mul_f32 v[60:61], v[60:61], v[60:61]
    v_pk_mul_f32 v[62:63], v[62:63], v[62:63]
    v_cvt_pk_bf16_f32 v60, v60, v61
    v_cvt_pk_bf16_f32 v61, v62, v63
    ds_write_b64 v26, v[60:61] offset:96
    v_max_f32 v92, 0, v92
    v_max_f32 v93, 0, v93
    v_max_f32 v94, 0, v94
    v_max_f32 v95, 0, v95
    v_pk_mul_f32 v[92:93], v[92:93], v[92:93]
    v_pk_mul_f32 v[94:95], v[94:95], v[94:95]
    v_cvt_pk_bf16_f32 v92, v92, v93
    v_cvt_pk_bf16_f32 v93, v94, v95
    ds_write_b64 v26, v[92:93] offset:4448
    v_max_f32 v64, 0, v64
    v_max_f32 v65, 0, v65
    v_max_f32 v66, 0, v66
    v_max_f32 v67, 0, v67
    v_pk_mul_f32 v[64:65], v[64:65], v[64:65]
    v_pk_mul_f32 v[66:67], v[66:67], v[66:67]
    v_cvt_pk_bf16_f32 v64, v64, v65
    v_cvt_pk_bf16_f32 v65, v66, v67
    ds_write_b64 v26, v[64:65] offset:128
    v_max_f32 v96, 0, v96
    v_max_f32 v97, 0, v97
    v_max_f32 v98, 0, v98
    v_max_f32 v99, 0, v99
    v_pk_mul_f32 v[96:97], v[96:97], v[96:97]
    v_pk_mul_f32 v[98:99], v[98:99], v[98:99]
    v_cvt_pk_bf16_f32 v96, v96, v97
    v_cvt_pk_bf16_f32 v97, v98, v99
    ds_write_b64 v26, v[96:97] offset:4480
    v_max_f32 v68, 0, v68
    v_max_f32 v69, 0, v69
    v_max_f32 v70, 0, v70
    v_max_f32 v71, 0, v71
    v_pk_mul_f32 v[68:69], v[68:69], v[68:69]
    v_pk_mul_f32 v[70:71], v[70:71], v[70:71]
    v_cvt_pk_bf16_f32 v68, v68, v69
    v_cvt_pk_bf16_f32 v69, v70, v71
    ds_write_b64 v26, v[68:69] offset:160
    v_max_f32 v100, 0, v100
    v_max_f32 v101, 0, v101
    v_max_f32 v102, 0, v102
    v_max_f32 v103, 0, v103
    v_pk_mul_f32 v[100:101], v[100:101], v[100:101]
    v_pk_mul_f32 v[102:103], v[102:103], v[102:103]
    v_cvt_pk_bf16_f32 v100, v100, v101
    v_cvt_pk_bf16_f32 v101, v102, v103
    ds_write_b64 v26, v[100:101] offset:4512
    v_max_f32 v72, 0, v72
    v_max_f32 v73, 0, v73
    v_max_f32 v74, 0, v74
    v_max_f32 v75, 0, v75
    v_pk_mul_f32 v[72:73], v[72:73], v[72:73]
    v_pk_mul_f32 v[74:75], v[74:75], v[74:75]
    v_cvt_pk_bf16_f32 v72, v72, v73
    v_cvt_pk_bf16_f32 v73, v74, v75
    ds_write_b64 v26, v[72:73] offset:192
    v_max_f32 v104, 0, v104
    v_max_f32 v105, 0, v105
    v_max_f32 v106, 0, v106
    v_max_f32 v107, 0, v107
    v_pk_mul_f32 v[104:105], v[104:105], v[104:105]
    v_pk_mul_f32 v[106:107], v[106:107], v[106:107]
    v_cvt_pk_bf16_f32 v104, v104, v105
    v_cvt_pk_bf16_f32 v105, v106, v107
    ds_write_b64 v26, v[104:105] offset:4544
    v_max_f32 v76, 0, v76
    v_max_f32 v77, 0, v77
    v_max_f32 v78, 0, v78
    v_max_f32 v79, 0, v79
    v_pk_mul_f32 v[76:77], v[76:77], v[76:77]
    v_pk_mul_f32 v[78:79], v[78:79], v[78:79]
    v_cvt_pk_bf16_f32 v76, v76, v77
    v_cvt_pk_bf16_f32 v77, v78, v79
    ds_write_b64 v26, v[76:77] offset:224
    v_max_f32 v108, 0, v108
    v_max_f32 v109, 0, v109
    v_max_f32 v110, 0, v110
    v_max_f32 v111, 0, v111
    v_pk_mul_f32 v[108:109], v[108:109], v[108:109]
    v_pk_mul_f32 v[110:111], v[110:111], v[110:111]
    v_cvt_pk_bf16_f32 v108, v108, v109
    v_cvt_pk_bf16_f32 v109, v110, v111
    ds_write_b64 v26, v[108:109] offset:4576
    s_waitcnt lgkmcnt(0)
    s_barrier
    ds_read_b128 v[112:115], v28 offset:0
    ds_read_b128 v[116:119], v28 offset:1088
    ds_read_b128 v[120:123], v28 offset:2176
    ds_read_b128 v[124:127], v28 offset:3264
    ds_read_b128 v[128:131], v28 offset:4352
    ds_read_b128 v[132:135], v28 offset:5440
    ds_read_b128 v[136:139], v28 offset:6528
    ds_read_b128 v[140:143], v28 offset:7616
    s_mov_b32 s28, 0
    s_waitcnt lgkmcnt(7)
    buffer_store_dwordx4 v[112:115], v29, s[16:19], s28 offen sc0 sc1
    s_mov_b32 s28, 13824
    s_waitcnt lgkmcnt(6)
    buffer_store_dwordx4 v[116:119], v29, s[16:19], s28 offen sc0 sc1
    s_mov_b32 s28, 27648
    s_waitcnt lgkmcnt(5)
    buffer_store_dwordx4 v[120:123], v29, s[16:19], s28 offen sc0 sc1
    s_mov_b32 s28, 41472
    s_waitcnt lgkmcnt(4)
    buffer_store_dwordx4 v[124:127], v29, s[16:19], s28 offen sc0 sc1
    s_mov_b32 s28, 55296
    s_waitcnt lgkmcnt(3)
    buffer_store_dwordx4 v[128:131], v29, s[16:19], s28 offen sc0 sc1
    s_mov_b32 s28, 69120
    s_waitcnt lgkmcnt(2)
    buffer_store_dwordx4 v[132:135], v29, s[16:19], s28 offen sc0 sc1
    s_mov_b32 s28, 82944
    s_waitcnt lgkmcnt(1)
    buffer_store_dwordx4 v[136:139], v29, s[16:19], s28 offen sc0 sc1
    s_mov_b32 s28, 96768
    s_waitcnt lgkmcnt(0)
    buffer_store_dwordx4 v[140:143], v29, s[16:19], s28 offen sc0 sc1
    s_endpgm
L_ffn1_kernel_loader:
    s_and_b32 s20, s32, 3
    s_mov_b32 s25, 1280
    v_mul_u32_u24 v5, 32, v4
    v_lshrrev_b32 v6, 3, v1
    v_add_u32 v5, v5, v6
    v_and_b32 v6, 7, v1
    v_add_u32 v8, 0, v5
    v_bfe_u32 v7, v8, 1, 3
    v_xor_b32 v7, v7, v6
    v_add_u32 v8, s22, v8
    v_mul_lo_u32 v8, v8, s25
    v_lshl_add_u32 v8, v7, 4, v8
    v_add_u32 v9, 8, v5
    v_bfe_u32 v7, v9, 1, 3
    v_xor_b32 v7, v7, v6
    v_add_u32 v9, s22, v9
    v_mul_lo_u32 v9, v9, s25
    v_lshl_add_u32 v9, v7, 4, v9
    v_add_u32 v10, 16, v5
    v_bfe_u32 v7, v10, 1, 3
    v_xor_b32 v7, v7, v6
    v_add_u32 v10, s22, v10
    v_mul_lo_u32 v10, v10, s25
    v_lshl_add_u32 v10, v7, 4, v10
    v_add_u32 v11, 24, v5
    v_bfe_u32 v7, v11, 1, 3
    v_xor_b32 v7, v7, v6
    v_add_u32 v11, s22, v11
    v_mul_lo_u32 v11, v11, s25
    v_lshl_add_u32 v11, v7, 4, v11
    s_mov_b32 s25, 3456
    v_lshrrev_b32 v5, 4, v1
    v_and_b32 v6, 15, v1
    v_lshlrev_b32 v7, 1, v5
    v_xor_b32 v7, v7, v6
    v_lshl_add_u32 v12, v4, 4, v5
    v_add_u32 v12, 0, v12
    v_mul_lo_u32 v12, v12, s25
    v_lshl_add_u32 v7, v7, 4, s24
    v_add_u32 v12, v12, v7
    v_lshlrev_b32 v7, 1, v5
    v_xor_b32 v7, v7, v6
    v_lshl_add_u32 v13, v4, 4, v5
    v_add_u32 v13, 4, v13
    v_mul_lo_u32 v13, v13, s25
    v_lshl_add_u32 v7, v7, 4, s24
    v_add_u32 v13, v13, v7
    v_lshlrev_b32 v7, 1, v5
    v_xor_b32 v7, v7, v6
    v_xor_b32 v7, 8, v7
    v_lshl_add_u32 v14, v4, 4, v5
    v_add_u32 v14, 8, v14
    v_mul_lo_u32 v14, v14, s25
    v_lshl_add_u32 v7, v7, 4, s24
    v_add_u32 v14, v14, v7
    v_lshlrev_b32 v7, 1, v5
    v_xor_b32 v7, v7, v6
    v_xor_b32 v7, 8, v7
    v_lshl_add_u32 v15, v4, 4, v5
    v_add_u32 v15, 12, v15
    v_mul_lo_u32 v15, v15, s25
    v_lshl_add_u32 v7, v7, 4, s24
    v_add_u32 v15, v15, v7
    s_lshl_b32 s21, s20, 12
    s_add_u32 s21, s21, 16384
    s_mul_i32 s20, s20, 4096
    s_waitcnt lgkmcnt(0)
    s_mov_b32 s6, 2621440
    s_mov_b32 s7, 0x00020000
    s_mov_b32 s10, 2211840
    s_mov_b32 s11, 0x00020000
    s_add_u32 m0, s21, 0
    s_nop 0
    buffer_load_dwordx4 v12, s[8:11], s29 offen lds
    s_add_u32 m0, s21, 1024
    s_nop 0
    buffer_load_dwordx4 v13, s[8:11], s29 offen lds
    s_add_u32 m0, s21, 2048
    s_nop 0
    buffer_load_dwordx4 v14, s[8:11], s29 offen lds
    s_add_u32 m0, s21, 3072
    s_nop 0
    buffer_load_dwordx4 v15, s[8:11], s29 offen lds
    s_add_u32 m0, s20, 0
    s_nop 0
    buffer_load_dwordx4 v8, s[4:7], s30 offen lds
    s_add_u32 m0, s20, 1024
    s_nop 0
    buffer_load_dwordx4 v9, s[4:7], s30 offen lds
    s_add_u32 m0, s20, 2048
    s_nop 0
    buffer_load_dwordx4 v10, s[4:7], s30 offen lds
    s_add_u32 m0, s20, 3072
    s_nop 0
    buffer_load_dwordx4 v11, s[4:7], s30 offen lds
    s_add_u32 s29, s29, 221184
    s_add_u32 s30, s30, 128
    s_cmp_ge_u32 s30, 1280
    s_cselect_b32 s24, 2211840, 0
    s_cselect_b32 s25, 1280, 0
    s_sub_u32 s29, s29, s24
    s_sub_u32 s30, s30, s25
    s_add_u32 m0, s21, 32768
    s_nop 0
    buffer_load_dwordx4 v12, s[8:11], s29 offen lds
    s_add_u32 m0, s21, 33792
    s_nop 0
    buffer_load_dwordx4 v13, s[8:11], s29 offen lds
    s_add_u32 m0, s21, 34816
    s_nop 0
    buffer_load_dwordx4 v14, s[8:11], s29 offen lds
    s_add_u32 m0, s21, 35840
    s_nop 0
    buffer_load_dwordx4 v15, s[8:11], s29 offen lds
    s_add_u32 m0, s20, 32768
    s_nop 0
    buffer_load_dwordx4 v8, s[4:7], s30 offen lds
    s_add_u32 m0, s20, 33792
    s_nop 0
    buffer_load_dwordx4 v9, s[4:7], s30 offen lds
    s_add_u32 m0, s20, 34816
    s_nop 0
    buffer_load_dwordx4 v10, s[4:7], s30 offen lds
    s_add_u32 m0, s20, 35840
    s_nop 0
    buffer_load_dwordx4 v11, s[4:7], s30 offen lds
    s_add_u32 s29, s29, 221184
    s_add_u32 s30, s30, 128
    s_cmp_ge_u32 s30, 1280
    s_cselect_b32 s24, 2211840, 0
    s_cselect_b32 s25, 1280, 0
    s_sub_u32 s29, s29, s24
    s_sub_u32 s30, s30, s25
    s_waitcnt vmcnt(8)
    s_barrier
    s_add_u32 m0, s21, 65536
    s_nop 0
    buffer_load_dwordx4 v12, s[8:11], s29 offen lds
    s_add_u32 m0, s21, 66560
    s_nop 0
    buffer_load_dwordx4 v13, s[8:11], s29 offen lds
    s_add_u32 m0, s21, 67584
    s_nop 0
    buffer_load_dwordx4 v14, s[8:11], s29 offen lds
    s_add_u32 m0, s21, 68608
    s_nop 0
    buffer_load_dwordx4 v15, s[8:11], s29 offen lds
    s_add_u32 m0, s20, 65536
    s_nop 0
    buffer_load_dwordx4 v8, s[4:7], s30 offen lds
    s_add_u32 m0, s20, 66560
    s_nop 0
    buffer_load_dwordx4 v9, s[4:7], s30 offen lds
    s_add_u32 m0, s20, 67584
    s_nop 0
    buffer_load_dwordx4 v10, s[4:7], s30 offen lds
    s_add_u32 m0, s20, 68608
    s_nop 0
    buffer_load_dwordx4 v11, s[4:7], s30 offen lds
    s_add_u32 s29, s29, 221184
    s_add_u32 s30, s30, 128
    s_cmp_ge_u32 s30, 1280
    s_cselect_b32 s24, 2211840, 0
    s_cselect_b32 s25, 1280, 0
    s_sub_u32 s29, s29, s24
    s_sub_u32 s30, s30, s25
    s_add_u32 m0, s21, 98304
    s_nop 0
    buffer_load_dwordx4 v12, s[8:11], s29 offen lds
    s_add_u32 m0, s21, 99328
    s_nop 0
    buffer_load_dwordx4 v13, s[8:11], s29 offen lds
    s_add_u32 m0, s21, 100352
    s_nop 0
    buffer_load_dwordx4 v14, s[8:11], s29 offen lds
    s_add_u32 m0, s21, 101376
    s_nop 0
    buffer_load_dwordx4 v15, s[8:11], s29 offen lds
    s_add_u32 m0, s20, 98304
    s_nop 0
    buffer_load_dwordx4 v8, s[4:7], s30 offen lds
    s_add_u32 m0, s20, 99328
    s_nop 0
    buffer_load_dwordx4 v9, s[4:7], s30 offen lds
    s_add_u32 m0, s20, 100352
    s_nop 0
    buffer_load_dwordx4 v10, s[4:7], s30 offen lds
    s_add_u32 m0, s20, 101376
    s_nop 0
    buffer_load_dwordx4 v11, s[4:7], s30 offen lds
    s_add_u32 s29, s29, 221184
    s_add_u32 s30, s30, 128
    s_cmp_ge_u32 s30, 1280
    s_cselect_b32 s24, 2211840, 0
    s_cselect_b32 s25, 1280, 0
    s_sub_u32 s29, s29, s24
    s_sub_u32 s30, s30, s25
    s_waitcnt vmcnt(16)
    s_barrier
    s_add_u32 m0, s21, 131072
    s_nop 0
    buffer_load_dwordx4 v12, s[8:11], s29 offen lds
    s_add_u32 m0, s21, 132096
    s_nop 0
    buffer_load_dwordx4 v13, s[8:11], s29 offen lds
    s_add_u32 m0, s21, 133120
    s_nop 0
    buffer_load_dwordx4 v14, s[8:11], s29 offen lds
    s_add_u32 m0, s21, 134144
    s_nop 0
    buffer_load_dwordx4 v15, s[8:11], s29 offen lds
    s_add_u32 m0, s20, 131072
    s_nop 0
    buffer_load_dwordx4 v8, s[4:7], s30 offen lds
    s_add_u32 m0, s20, 132096
    s_nop 0
    buffer_load_dwordx4 v9, s[4:7], s30 offen lds
    s_add_u32 m0, s20, 133120
    s_nop 0
    buffer_load_dwordx4 v10, s[4:7], s30 offen lds
    s_add_u32 m0, s20, 134144
    s_nop 0
    buffer_load_dwordx4 v11, s[4:7], s30 offen lds
    s_add_u32 s29, s29, 221184
    s_add_u32 s30, s30, 128
    s_cmp_ge_u32 s30, 1280
    s_cselect_b32 s24, 2211840, 0
    s_cselect_b32 s25, 1280, 0
    s_sub_u32 s29, s29, s24
    s_sub_u32 s30, s30, s25
    s_waitcnt vmcnt(16)
    s_barrier
    s_add_u32 m0, s21, 0
    s_nop 0
    buffer_load_dwordx4 v12, s[8:11], s29 offen lds
    s_add_u32 m0, s21, 1024
    s_nop 0
    buffer_load_dwordx4 v13, s[8:11], s29 offen lds
    s_add_u32 m0, s21, 2048
    s_nop 0
    buffer_load_dwordx4 v14, s[8:11], s29 offen lds
    s_add_u32 m0, s21, 3072
    s_nop 0
    buffer_load_dwordx4 v15, s[8:11], s29 offen lds
    s_add_u32 m0, s20, 0
    s_nop 0
    buffer_load_dwordx4 v8, s[4:7], s30 offen lds
    s_add_u32 m0, s20, 1024
    s_nop 0
    buffer_load_dwordx4 v9, s[4:7], s30 offen lds
    s_add_u32 m0, s20, 2048
    s_nop 0
    buffer_load_dwordx4 v10, s[4:7], s30 offen lds
    s_add_u32 m0, s20, 3072
    s_nop 0
    buffer_load_dwordx4 v11, s[4:7], s30 offen lds
    s_add_u32 s29, s29, 221184
    s_add_u32 s30, s30, 128
    s_cmp_ge_u32 s30, 1280
    s_cselect_b32 s24, 2211840, 0
    s_cselect_b32 s25, 1280, 0
    s_sub_u32 s29, s29, s24
    s_sub_u32 s30, s30, s25
    s_waitcnt vmcnt(16)
    s_barrier
    s_add_u32 m0, s21, 32768
    s_nop 0
    buffer_load_dwordx4 v12, s[8:11], s29 offen lds
    s_add_u32 m0, s21, 33792
    s_nop 0
    buffer_load_dwordx4 v13, s[8:11], s29 offen lds
    s_add_u32 m0, s21, 34816
    s_nop 0
    buffer_load_dwordx4 v14, s[8:11], s29 offen lds
    s_add_u32 m0, s21, 35840
    s_nop 0
    buffer_load_dwordx4 v15, s[8:11], s29 offen lds
    s_add_u32 m0, s20, 32768
    s_nop 0
    buffer_load_dwordx4 v8, s[4:7], s30 offen lds
    s_add_u32 m0, s20, 33792
    s_nop 0
    buffer_load_dwordx4 v9, s[4:7], s30 offen lds
    s_add_u32 m0, s20, 34816
    s_nop 0
    buffer_load_dwordx4 v10, s[4:7], s30 offen lds
    s_add_u32 m0, s20, 35840
    s_nop 0
    buffer_load_dwordx4 v11, s[4:7], s30 offen lds
    s_add_u32 s29, s29, 221184
    s_add_u32 s30, s30, 128
    s_cmp_ge_u32 s30, 1280
    s_cselect_b32 s24, 2211840, 0
    s_cselect_b32 s25, 1280, 0
    s_sub_u32 s29, s29, s24
    s_sub_u32 s30, s30, s25
    s_waitcnt vmcnt(16)
    s_barrier
    s_add_u32 m0, s21, 65536
    s_nop 0
    buffer_load_dwordx4 v12, s[8:11], s29 offen lds
    s_add_u32 m0, s21, 66560
    s_nop 0
    buffer_load_dwordx4 v13, s[8:11], s29 offen lds
    s_add_u32 m0, s21, 67584
    s_nop 0
    buffer_load_dwordx4 v14, s[8:11], s29 offen lds
    s_add_u32 m0, s21, 68608
    s_nop 0
    buffer_load_dwordx4 v15, s[8:11], s29 offen lds
    s_add_u32 m0, s20, 65536
    s_nop 0
    buffer_load_dwordx4 v8, s[4:7], s30 offen lds
    s_add_u32 m0, s20, 66560
    s_nop 0
    buffer_load_dwordx4 v9, s[4:7], s30 offen lds
    s_add_u32 m0, s20, 67584
    s_nop 0
    buffer_load_dwordx4 v10, s[4:7], s30 offen lds
    s_add_u32 m0, s20, 68608
    s_nop 0
    buffer_load_dwordx4 v11, s[4:7], s30 offen lds
    s_add_u32 s29, s29, 221184
    s_add_u32 s30, s30, 128
    s_cmp_ge_u32 s30, 1280
    s_cselect_b32 s24, 2211840, 0
    s_cselect_b32 s25, 1280, 0
    s_sub_u32 s29, s29, s24
    s_sub_u32 s30, s30, s25
    s_waitcnt vmcnt(16)
    s_barrier
    s_add_u32 m0, s21, 98304
    s_nop 0
    buffer_load_dwordx4 v12, s[8:11], s29 offen lds
    s_add_u32 m0, s21, 99328
    s_nop 0
    buffer_load_dwordx4 v13, s[8:11], s29 offen lds
    s_add_u32 m0, s21, 100352
    s_nop 0
    buffer_load_dwordx4 v14, s[8:11], s29 offen lds
    s_add_u32 m0, s21, 101376
    s_nop 0
    buffer_load_dwordx4 v15, s[8:11], s29 offen lds
    s_add_u32 m0, s20, 98304
    s_nop 0
    buffer_load_dwordx4 v8, s[4:7], s30 offen lds
    s_add_u32 m0, s20, 99328
    s_nop 0
    buffer_load_dwordx4 v9, s[4:7], s30 offen lds
    s_add_u32 m0, s20, 100352
    s_nop 0
    buffer_load_dwordx4 v10, s[4:7], s30 offen lds
    s_add_u32 m0, s20, 101376
    s_nop 0
    buffer_load_dwordx4 v11, s[4:7], s30 offen lds
    s_add_u32 s29, s29, 221184
    s_add_u32 s30, s30, 128
    s_cmp_ge_u32 s30, 1280
    s_cselect_b32 s24, 2211840, 0
    s_cselect_b32 s25, 1280, 0
    s_sub_u32 s29, s29, s24
    s_sub_u32 s30, s30, s25
    s_waitcnt vmcnt(16)
    s_barrier
    s_add_u32 m0, s21, 131072
    s_nop 0
    buffer_load_dwordx4 v12, s[8:11], s29 offen lds
    s_add_u32 m0, s21, 132096
    s_nop 0
    buffer_load_dwordx4 v13, s[8:11], s29 offen lds
    s_add_u32 m0, s21, 133120
    s_nop 0
    buffer_load_dwordx4 v14, s[8:11], s29 offen lds
    s_add_u32 m0, s21, 134144
    s_nop 0
    buffer_load_dwordx4 v15, s[8:11], s29 offen lds
    s_add_u32 m0, s20, 131072
    s_nop 0
    buffer_load_dwordx4 v8, s[4:7], s30 offen lds
    s_add_u32 m0, s20, 132096
    s_nop 0
    buffer_load_dwordx4 v9, s[4:7], s30 offen lds
    s_add_u32 m0, s20, 133120
    s_nop 0
    buffer_load_dwordx4 v10, s[4:7], s30 offen lds
    s_add_u32 m0, s20, 134144
    s_nop 0
    buffer_load_dwordx4 v11, s[4:7], s30 offen lds
    s_waitcnt vmcnt(16)
    s_barrier
    s_waitcnt vmcnt(8)
    s_barrier
    s_waitcnt vmcnt(0)
    s_barrier
L_ffn1_kernel_end:
    s_endpgm
.section .rodata,"a"
.p2align 6
.amdhsa_kernel ffn1_kernel
  .amdhsa_next_free_vgpr 192
  .amdhsa_next_free_sgpr 102
  .amdhsa_accum_offset 192
  .amdhsa_group_segment_fixed_size 0
  .amdhsa_kernarg_size 64
  .amdhsa_user_sgpr_count 2
  .amdhsa_user_sgpr_kernarg_segment_ptr 1
  .amdhsa_system_sgpr_workgroup_id_x 1
.end_amdhsa_kernel
.text

.globl ffn2_kernel
.p2align 8
.type ffn2_kernel,@function
ffn2_kernel:
    s_cmp_ge_u32 s2, 224
    s_cbranch_scc1 L_ffn2_kernel_end
    s_load_dwordx2 s[4:5], s[0:1], 56
    s_load_dwordx2 s[8:9], s[0:1], 24
    s_load_dwordx2 s[12:13], s[0:1], 32
    s_load_dwordx2 s[16:17], s[0:1], 40
    s_and_b32 s24, s2, 7
    s_lshr_b32 s25, s2, 3
    s_mul_i32 s24, s24, 28
    s_add_u32 s24, s24, s25
    s_mul_i32 s26, s24, 205
    s_lshr_b32 s26, s26, 11
    s_mul_i32 s27, s26, 10
    s_sub_u32 s27, s24, s27
    s_lshr_b32 s31, s2, 3
    s_cmp_ge_u32 s31, 27
    s_cselect_b32 s24, 27, 0
    s_sub_u32 s31, s31, s24
    s_mul_i32 s29, s31, 81920
    s_lshl_b32 s30, s31, 7
    s_mul_i32 s22, s26, 96
    s_mul_i32 s23, s27, 64
    v_and_b32 v1, 63, v0
    v_lshrrev_b32 v2, 4, v1
    v_and_b32 v3, 15, v1
    v_lshrrev_b32 v4, 6, v0
    s_nop 1
    v_readfirstlane_b32 s32, v4
    v_and_b32 v4, 3, v4
    s_lshl_b32 s24, s23, 1
    s_cmp_ge_u32 s32, 4
    s_cbranch_scc1 L_ffn2_kernel_loader
    v_and_b32 v30, 1, v4
    v_lshrrev_b32 v4, 1, v4
    v_lshrrev_b32 v6, 1, v3
    v_mul_u32_u24 v5, 6144, v4
    v_lshl_add_u32 v5, v3, 7, v5
    v_xor_b32 v7, 0, v2
    v_xor_b32 v7, v7, v6
    v_lshl_add_u32 v16, v7, 4, v5
    v_xor_b32 v7, 4, v2
    v_xor_b32 v7, v7, v6
    v_lshl_add_u32 v17, v7, 4, v5
    v_bfe_u32 v5, v1, 2, 2
    v_and_b32 v6, 1, v2
    v_lshrrev_b32 v7, 1, v5
    v_lshl_add_u32 v6, v6, 1, v7
    v_lshl_add_u32 v5, v2, 3, v5
    v_lshlrev_b32 v5, 7, v5
    v_and_b32 v7, 3, v1
    v_lshl_add_u32 v5, v7, 3, v5
    v_add_u32 v5, 12288, v5
    v_mul_u32_u24 v7, 2, v30
    v_add_u32 v18, 0, v7
    v_xor_b32 v18, v18, v6
    v_lshl_add_u32 v18, v18, 5, v5
    v_add_u32 v19, 1, v7
    v_xor_b32 v19, v19, v6
    v_lshl_add_u32 v19, v19, 5, v5
    v_lshlrev_b32 v27, 6, v30
    v_lshl_add_u32 v27, v2, 3, v27
    v_add_u32 v27, s24, v27
    s_waitcnt lgkmcnt(0)
    s_mov_b32 s14, 1280
    s_mov_b32 s15, 0x00020000
    s_mov_b32 s18, 2621440
    s_mov_b32 s19, 0x00020000
    buffer_load_dwordx2 v[32:33], v27, s[12:15], 0 offen offset:0
    buffer_load_dwordx2 v[34:35], v27, s[12:15], 0 offen offset:32
    v_mul_u32_u24 v26, 48, v4
    v_add_u32 v26, v26, v3
    v_mul_u32_u24 v26, 144, v26
    v_mul_u32_u24 v5, 64, v30
    v_lshl_add_u32 v5, v2, 3, v5
    v_add_u32 v26, v26, v5
    v_lshrrev_b32 v4, 6, v0
    v_mul_u32_u24 v4, 24, v4
    v_lshrrev_b32 v5, 3, v1
    v_add_u32 v5, v5, v4
    v_and_b32 v6, 7, v1
    v_mul_u32_u24 v28, 144, v5
    v_lshl_add_u32 v28, v6, 4, v28
    v_add_u32 v5, s22, v5
    v_mul_u32_u24 v29, 1280, v5
    v_lshl_add_u32 v7, v6, 4, s24
    v_add_u32 v29, v29, v7
    s_waitcnt vmcnt(0)
    v_lshlrev_b32 v48, 16, v32
    v_and_b32 v49, 0xffff0000, v32
    v_lshlrev_b32 v50, 16, v33
    v_and_b32 v51, 0xffff0000, v33
    v_lshlrev_b32 v56, 16, v32
    v_and_b32 v57, 0xffff0000, v32
    v_lshlrev_b32 v58, 16, v33
    v_and_b32 v59, 0xffff0000, v33
    v_lshlrev_b32 v64, 16, v32
    v_and_b32 v65, 0xffff0000, v32
    v_lshlrev_b32 v66, 16, v33
    v_and_b32 v67, 0xffff0000, v33
    v_lshlrev_b32 v52, 16, v34
    v_and_b32 v53, 0xffff0000, v34
    v_lshlrev_b32 v54, 16, v35
    v_and_b32 v55, 0xffff0000, v35
    v_lshlrev_b32 v60, 16, v34
    v_and_b32 v61, 0xffff0000, v34
    v_lshlrev_b32 v62, 16, v35
    v_and_b32 v63, 0xffff0000, v35
    v_lshlrev_b32 v68, 16, v34
    v_and_b32 v69, 0xffff0000, v34
    v_lshlrev_b32 v70, 16, v35
    v_and_b32 v71, 0xffff0000, v35
    s_barrier
    ds_read_b128 v[88:91], v16 offset:0
    ds_read_b128 v[92:95], v16 offset:2048
    ds_read_b128 v[96:99], v16 offset:4096
    ds_read_b64_tr_b16 v[72:73], v18 offset:0
    ds_read_b64_tr_b16 v[74:75], v18 offset:512
    ds_read_b64_tr_b16 v[76:77], v19 offset:0
    ds_read_b64_tr_b16 v[78:79], v19 offset:512
    s_waitcnt lgkmcnt(0)
    v_mfma_f32_16x16x32_bf16 v[48:51], v[72:75], v[88:91], v[48:51]
    ds_read_b128 v[100:103], v17 offset:0
    ds_read_b128 v[104:107], v17 offset:2048
    v_mfma_f32_16x16x32_bf16 v[52:55], v[76:79], v[88:91], v[52:55]
    ds_read_b128 v[108:111], v17 offset:4096
    v_mfma_f32_16x16x32_bf16 v[56:59], v[72:75], v[92:95], v[56:59]
    ds_read_b64_tr_b16 v[80:81], v18 offset:4096
    v_mfma_f32_16x16x32_bf16 v[60:63], v[76:79], v[92:95], v[60:63]
    ds_read_b64_tr_b16 v[82:83], v18 offset:4608
    v_mfma_f32_16x16x32_bf16 v[64:67], v[72:75], v[96:99], v[64:67]
    ds_read_b64_tr_b16 v[84:85], v19 offset:4096
    v_mfma_f32_16x16x32_bf16 v[68:71], v[76:79], v[96:99], v[68:71]
    ds_read_b64_tr_b16 v[86:87], v19 offset:4608
    s_barrier
    v_add_u32 v16, 0x5000, v16
    v_add_u32 v17, 0x5000, v17
    v_add_u32 v18, 0x5000, v18
    v_add_u32 v19, 0x5000, v19
    s_waitcnt lgkmcnt(0)
    v_mfma_f32_16x16x32_bf16 v[48:51], v[80:83], v[100:103], v[48:51]
    ds_read_b128 v[88:91], v16 offset:0
    ds_read_b128 v[92:95], v16 offset:2048
    v_mfma_f32_16x16x32_bf16 v[52:55], v[84:87], v[100:103], v[52:55]
    ds_read_b128 v[96:99], v16 offset:4096
    v_mfma_f32_16x16x32_bf16 v[56:59], v[80:83], v[104:107], v[56:59]
    ds_read_b64_tr_b16 v[72:73], v18 offset:0
    v_mfma_f32_16x16x32_bf16 v[60:63], v[84:87], v[104:107], v[60:63]
    ds_read_b64_tr_b16 v[74:75], v18 offset:512
    v_mfma_f32_16x16x32_bf16 v[64:67], v[80:83], v[108:111], v[64:67]
    ds_read_b64_tr_b16 v[76:77], v19 offset:0
    v_mfma_f32_16x16x32_bf16 v[68:71], v[84:87], v[108:111], v[68:71]
    ds_read_b64_tr_b16 v[78:79], v19 offset:512
    s_waitcnt lgkmcnt(0)
    v_mfma_f32_16x16x32_bf16 v[48:51], v[72:75], v[88:91], v[48:51]
    ds_read_b128 v[100:103], v17 offset:0
    ds_read_b128 v[104:107], v17 offset:2048
    v_mfma_f32_16x16x32_bf16 v[52:55], v[76:79], v[88:91], v[52:55]
    ds_read_b128 v[108:111], v17 offset:4096
    v_mfma_f32_16x16x32_bf16 v[56:59], v[72:75], v[92:95], v[56:59]
    ds_read_b64_tr_b16 v[80:81], v18 offset:4096
    v_mfma_f32_16x16x32_bf16 v[60:63], v[76:79], v[92:95], v[60:63]
    ds_read_b64_tr_b16 v[82:83], v18 offset:4608
    v_mfma_f32_16x16x32_bf16 v[64:67], v[72:75], v[96:99], v[64:67]
    ds_read_b64_tr_b16 v[84:85], v19 offset:4096
    v_mfma_f32_16x16x32_bf16 v[68:71], v[76:79], v[96:99], v[68:71]
    ds_read_b64_tr_b16 v[86:87], v19 offset:4608
    s_barrier
    v_add_u32 v16, 0x5000, v16
    v_add_u32 v17, 0x5000, v17
    v_add_u32 v18, 0x5000, v18
    v_add_u32 v19, 0x5000, v19
    s_waitcnt lgkmcnt(0)
    v_mfma_f32_16x16x32_bf16 v[48:51], v[80:83], v[100:103], v[48:51]
    ds_read_b128 v[88:91], v16 offset:0
    ds_read_b128 v[92:95], v16 offset:2048
    v_mfma_f32_16x16x32_bf16 v[52:55], v[84:87], v[100:103], v[52:55]
    ds_read_b128 v[96:99], v16 offset:4096
    v_mfma_f32_16x16x32_bf16 v[56:59], v[80:83], v[104:107], v[56:59]
    ds_read_b64_tr_b16 v[72:73], v18 offset:0
    v_mfma_f32_16x16x32_bf16 v[60:63], v[84:87], v[104:107], v[60:63]
    ds_read_b64_tr_b16 v[74:75], v18 offset:512
    v_mfma_f32_16x16x32_bf16 v[64:67], v[80:83], v[108:111], v[64:67]
    ds_read_b64_tr_b16 v[76:77], v19 offset:0
    v_mfma_f32_16x16x32_bf16 v[68:71], v[84:87], v[108:111], v[68:71]
    ds_read_b64_tr_b16 v[78:79], v19 offset:512
    s_waitcnt lgkmcnt(0)
    v_mfma_f32_16x16x32_bf16 v[48:51], v[72:75], v[88:91], v[48:51]
    ds_read_b128 v[100:103], v17 offset:0
    ds_read_b128 v[104:107], v17 offset:2048
    v_mfma_f32_16x16x32_bf16 v[52:55], v[76:79], v[88:91], v[52:55]
    ds_read_b128 v[108:111], v17 offset:4096
    v_mfma_f32_16x16x32_bf16 v[56:59], v[72:75], v[92:95], v[56:59]
    ds_read_b64_tr_b16 v[80:81], v18 offset:4096
    v_mfma_f32_16x16x32_bf16 v[60:63], v[76:79], v[92:95], v[60:63]
    ds_read_b64_tr_b16 v[82:83], v18 offset:4608
    v_mfma_f32_16x16x32_bf16 v[64:67], v[72:75], v[96:99], v[64:67]
    ds_read_b64_tr_b16 v[84:85], v19 offset:4096
    v_mfma_f32_16x16x32_bf16 v[68:71], v[76:79], v[96:99], v[68:71]
    ds_read_b64_tr_b16 v[86:87], v19 offset:4608
    s_barrier
    v_add_u32 v16, 0x5000, v16
    v_add_u32 v17, 0x5000, v17
    v_add_u32 v18, 0x5000, v18
    v_add_u32 v19, 0x5000, v19
    s_waitcnt lgkmcnt(0)
    v_mfma_f32_16x16x32_bf16 v[48:51], v[80:83], v[100:103], v[48:51]
    ds_read_b128 v[88:91], v16 offset:0
    ds_read_b128 v[92:95], v16 offset:2048
    v_mfma_f32_16x16x32_bf16 v[52:55], v[84:87], v[100:103], v[52:55]
    ds_read_b128 v[96:99], v16 offset:4096
    v_mfma_f32_16x16x32_bf16 v[56:59], v[80:83], v[104:107], v[56:59]
    ds_read_b64_tr_b16 v[72:73], v18 offset:0
    v_mfma_f32_16x16x32_bf16 v[60:63], v[84:87], v[104:107], v[60:63]
    ds_read_b64_tr_b16 v[74:75], v18 offset:512
    v_mfma_f32_16x16x32_bf16 v[64:67], v[80:83], v[108:111], v[64:67]
    ds_read_b64_tr_b16 v[76:77], v19 offset:0
    v_mfma_f32_16x16x32_bf16 v[68:71], v[84:87], v[108:111], v[68:71]
    ds_read_b64_tr_b16 v[78:79], v19 offset:512
    s_waitcnt lgkmcnt(0)
    v_mfma_f32_16x16x32_bf16 v[48:51], v[72:75], v[88:91], v[48:51]
    ds_read_b128 v[100:103], v17 offset:0
    ds_read_b128 v[104:107], v17 offset:2048
    v_mfma_f32_16x16x32_bf16 v[52:55], v[76:79], v[88:91], v[52:55]
    ds_read_b128 v[108:111], v17 offset:4096
    v_mfma_f32_16x16x32_bf16 v[56:59], v[72:75], v[92:95], v[56:59]
    ds_read_b64_tr_b16 v[80:81], v18 offset:4096
    v_mfma_f32_16x16x32_bf16 v[60:63], v[76:79], v[92:95], v[60:63]
    ds_read_b64_tr_b16 v[82:83], v18 offset:4608
    v_mfma_f32_16x16x32_bf16 v[64:67], v[72:75], v[96:99], v[64:67]
    ds_read_b64_tr_b16 v[84:85], v19 offset:4096
    v_mfma_f32_16x16x32_bf16 v[68:71], v[76:79], v[96:99], v[68:71]
    ds_read_b64_tr_b16 v[86:87], v19 offset:4608
    s_barrier
    v_add_u32 v16, 0x5000, v16
    v_add_u32 v17, 0x5000, v17
    v_add_u32 v18, 0x5000, v18
    v_add_u32 v19, 0x5000, v19
    s_waitcnt lgkmcnt(0)
    v_mfma_f32_16x16x32_bf16 v[48:51], v[80:83], v[100:103], v[48:51]
    ds_read_b128 v[88:91], v16 offset:0
    ds_read_b128 v[92:95], v16 offset:2048
    v_mfma_f32_16x16x32_bf16 v[52:55], v[84:87], v[100:103], v[52:55]
    ds_read_b128 v[96:99], v16 offset:4096
    v_mfma_f32_16x16x32_bf16 v[56:59], v[80:83], v[104:107], v[56:59]
    ds_read_b64_tr_b16 v[72:73], v18 offset:0
    v_mfma_f32_16x16x32_bf16 v[60:63], v[84:87], v[104:107], v[60:63]
    ds_read_b64_tr_b16 v[74:75], v18 offset:512
    v_mfma_f32_16x16x32_bf16 v[64:67], v[80:83], v[108:111], v[64:67]
    ds_read_b64_tr_b16 v[76:77], v19 offset:0
    v_mfma_f32_16x16x32_bf16 v[68:71], v[84:87], v[108:111], v[68:71]
    ds_read_b64_tr_b16 v[78:79], v19 offset:512
    s_waitcnt lgkmcnt(0)
    v_mfma_f32_16x16x32_bf16 v[48:51], v[72:75], v[88:91], v[48:51]
    ds_read_b128 v[100:103], v17 offset:0
    ds_read_b128 v[104:107], v17 offset:2048
    v_mfma_f32_16x16x32_bf16 v[52:55], v[76:79], v[88:91], v[52:55]
    ds_read_b128 v[108:111], v17 offset:4096
    v_mfma_f32_16x16x32_bf16 v[56:59], v[72:75], v[92:95], v[56:59]
    ds_read_b64_tr_b16 v[80:81], v18 offset:4096
    v_mfma_f32_16x16x32_bf16 v[60:63], v[76:79], v[92:95], v[60:63]
    ds_read_b64_tr_b16 v[82:83], v18 offset:4608
    v_mfma_f32_16x16x32_bf16 v[64:67], v[72:75], v[96:99], v[64:67]
    ds_read_b64_tr_b16 v[84:85], v19 offset:4096
    v_mfma_f32_16x16x32_bf16 v[68:71], v[76:79], v[96:99], v[68:71]
    ds_read_b64_tr_b16 v[86:87], v19 offset:4608
    s_barrier
    v_add_u32 v16, 0x5000, v16
    v_add_u32 v17, 0x5000, v17
    v_add_u32 v18, 0x5000, v18
    v_add_u32 v19, 0x5000, v19
    s_waitcnt lgkmcnt(0)
    v_mfma_f32_16x16x32_bf16 v[48:51], v[80:83], v[100:103], v[48:51]
    ds_read_b128 v[88:91], v16 offset:0
    ds_read_b128 v[92:95], v16 offset:2048
    v_mfma_f32_16x16x32_bf16 v[52:55], v[84:87], v[100:103], v[52:55]
    ds_read_b128 v[96:99], v16 offset:4096
    v_mfma_f32_16x16x32_bf16 v[56:59], v[80:83], v[104:107], v[56:59]
    ds_read_b64_tr_b16 v[72:73], v18 offset:0
    v_mfma_f32_16x16x32_bf16 v[60:63], v[84:87], v[104:107], v[60:63]
    ds_read_b64_tr_b16 v[74:75], v18 offset:512
    v_mfma_f32_16x16x32_bf16 v[64:67], v[80:83], v[108:111], v[64:67]
    ds_read_b64_tr_b16 v[76:77], v19 offset:0
    v_mfma_f32_16x16x32_bf16 v[68:71], v[84:87], v[108:111], v[68:71]
    ds_read_b64_tr_b16 v[78:79], v19 offset:512
    s_waitcnt lgkmcnt(0)
    v_mfma_f32_16x16x32_bf16 v[48:51], v[72:75], v[88:91], v[48:51]
    ds_read_b128 v[100:103], v17 offset:0
    ds_read_b128 v[104:107], v17 offset:2048
    v_mfma_f32_16x16x32_bf16 v[52:55], v[76:79], v[88:91], v[52:55]
    ds_read_b128 v[108:111], v17 offset:4096
    v_mfma_f32_16x16x32_bf16 v[56:59], v[72:75], v[92:95], v[56:59]
    ds_read_b64_tr_b16 v[80:81], v18 offset:4096
    v_mfma_f32_16x16x32_bf16 v[60:63], v[76:79], v[92:95], v[60:63]
    ds_read_b64_tr_b16 v[82:83], v18 offset:4608
    v_mfma_f32_16x16x32_bf16 v[64:67], v[72:75], v[96:99], v[64:67]
    ds_read_b64_tr_b16 v[84:85], v19 offset:4096
    v_mfma_f32_16x16x32_bf16 v[68:71], v[76:79], v[96:99], v[68:71]
    ds_read_b64_tr_b16 v[86:87], v19 offset:4608
    s_barrier
    v_add_u32 v16, 0x5000, v16
    v_add_u32 v17, 0x5000, v17
    v_add_u32 v18, 0x5000, v18
    v_add_u32 v19, 0x5000, v19
    s_waitcnt lgkmcnt(0)
    v_mfma_f32_16x16x32_bf16 v[48:51], v[80:83], v[100:103], v[48:51]
    ds_read_b128 v[88:91], v16 offset:0
    ds_read_b128 v[92:95], v16 offset:2048
    v_mfma_f32_16x16x32_bf16 v[52:55], v[84:87], v[100:103], v[52:55]
    ds_read_b128 v[96:99], v16 offset:4096
    v_mfma_f32_16x16x32_bf16 v[56:59], v[80:83], v[104:107], v[56:59]
    ds_read_b64_tr_b16 v[72:73], v18 offset:0
    v_mfma_f32_16x16x32_bf16 v[60:63], v[84:87], v[104:107], v[60:63]
    ds_read_b64_tr_b16 v[74:75], v18 offset:512
    v_mfma_f32_16x16x32_bf16 v[64:67], v[80:83], v[108:111], v[64:67]
    ds_read_b64_tr_b16 v[76:77], v19 offset:0
    v_mfma_f32_16x16x32_bf16 v[68:71], v[84:87], v[108:111], v[68:71]
    ds_read_b64_tr_b16 v[78:79], v19 offset:512
    s_waitcnt lgkmcnt(0)
    v_mfma_f32_16x16x32_bf16 v[48:51], v[72:75], v[88:91], v[48:51]
    ds_read_b128 v[100:103], v17 offset:0
    ds_read_b128 v[104:107], v17 offset:2048
    v_mfma_f32_16x16x32_bf16 v[52:55], v[76:79], v[88:91], v[52:55]
    ds_read_b128 v[108:111], v17 offset:4096
    v_mfma_f32_16x16x32_bf16 v[56:59], v[72:75], v[92:95], v[56:59]
    ds_read_b64_tr_b16 v[80:81], v18 offset:4096
    v_mfma_f32_16x16x32_bf16 v[60:63], v[76:79], v[92:95], v[60:63]
    ds_read_b64_tr_b16 v[82:83], v18 offset:4608
    v_mfma_f32_16x16x32_bf16 v[64:67], v[72:75], v[96:99], v[64:67]
    ds_read_b64_tr_b16 v[84:85], v19 offset:4096
    v_mfma_f32_16x16x32_bf16 v[68:71], v[76:79], v[96:99], v[68:71]
    ds_read_b64_tr_b16 v[86:87], v19 offset:4608
    s_barrier
    v_add_u32 v16, 0x5000, v16
    v_add_u32 v17, 0x5000, v17
    v_add_u32 v18, 0x5000, v18
    v_add_u32 v19, 0x5000, v19
    s_waitcnt lgkmcnt(0)
    v_mfma_f32_16x16x32_bf16 v[48:51], v[80:83], v[100:103], v[48:51]
    ds_read_b128 v[88:91], v16 offset:0
    ds_read_b128 v[92:95], v16 offset:2048
    v_mfma_f32_16x16x32_bf16 v[52:55], v[84:87], v[100:103], v[52:55]
    ds_read_b128 v[96:99], v16 offset:4096
    v_mfma_f32_16x16x32_bf16 v[56:59], v[80:83], v[104:107], v[56:59]
    ds_read_b64_tr_b16 v[72:73], v18 offset:0
    v_mfma_f32_16x16x32_bf16 v[60:63], v[84:87], v[104:107], v[60:63]
    ds_read_b64_tr_b16 v[74:75], v18 offset:512
    v_mfma_f32_16x16x32_bf16 v[64:67], v[80:83], v[108:111], v[64:67]
    ds_read_b64_tr_b16 v[76:77], v19 offset:0
    v_mfma_f32_16x16x32_bf16 v[68:71], v[84:87], v[108:111], v[68:71]
    ds_read_b64_tr_b16 v[78:79], v19 offset:512
    s_waitcnt lgkmcnt(0)
    v_mfma_f32_16x16x32_bf16 v[48:51], v[72:75], v[88:91], v[48:51]
    ds_read_b128 v[100:103], v17 offset:0
    ds_read_b128 v[104:107], v17 offset:2048
    v_mfma_f32_16x16x32_bf16 v[52:55], v[76:79], v[88:91], v[52:55]
    ds_read_b128 v[108:111], v17 offset:4096
    v_mfma_f32_16x16x32_bf16 v[56:59], v[72:75], v[92:95], v[56:59]
    ds_read_b64_tr_b16 v[80:81], v18 offset:4096
    v_mfma_f32_16x16x32_bf16 v[60:63], v[76:79], v[92:95], v[60:63]
    ds_read_b64_tr_b16 v[82:83], v18 offset:4608
    v_mfma_f32_16x16x32_bf16 v[64:67], v[72:75], v[96:99], v[64:67]
    ds_read_b64_tr_b16 v[84:85], v19 offset:4096
    v_mfma_f32_16x16x32_bf16 v[68:71], v[76:79], v[96:99], v[68:71]
    ds_read_b64_tr_b16 v[86:87], v19 offset:4608
    s_barrier
    v_add_u32 v16, 0xfffdd000, v16
    v_add_u32 v17, 0xfffdd000, v17
    v_add_u32 v18, 0xfffdd000, v18
    v_add_u32 v19, 0xfffdd000, v19
    s_waitcnt lgkmcnt(0)
    v_mfma_f32_16x16x32_bf16 v[48:51], v[80:83], v[100:103], v[48:51]
    ds_read_b128 v[88:91], v16 offset:0
    ds_read_b128 v[92:95], v16 offset:2048
    v_mfma_f32_16x16x32_bf16 v[52:55], v[84:87], v[100:103], v[52:55]
    ds_read_b128 v[96:99], v16 offset:4096
    v_mfma_f32_16x16x32_bf16 v[56:59], v[80:83], v[104:107], v[56:59]
    ds_read_b64_tr_b16 v[72:73], v18 offset:0
    v_mfma_f32_16x16x32_bf16 v[60:63], v[84:87], v[104:107], v[60:63]
    ds_read_b64_tr_b16 v[74:75], v18 offset:512
    v_mfma_f32_16x16x32_bf16 v[64:67], v[80:83], v[108:111], v[64:67]
    ds_read_b64_tr_b16 v[76:77], v19 offset:0
    v_mfma_f32_16x16x32_bf16 v[68:71], v[84:87], v[108:111], v[68:71]
    ds_read_b64_tr_b16 v[78:79], v19 offset:512
    s_waitcnt lgkmcnt(0)
    v_mfma_f32_16x16x32_bf16 v[48:51], v[72:75], v[88:91], v[48:51]
    ds_read_b128 v[100:103], v17 offset:0
    ds_read_b128 v[104:107], v17 offset:2048
    v_mfma_f32_16x16x32_bf16 v[52:55], v[76:79], v[88:91], v[52:55]
    ds_read_b128 v[108:111], v17 offset:4096
    v_mfma_f32_16x16x32_bf16 v[56:59], v[72:75], v[92:95], v[56:59]
    ds_read_b64_tr_b16 v[80:81], v18 offset:4096
    v_mfma_f32_16x16x32_bf16 v[60:63], v[76:79], v[92:95], v[60:63]
    ds_read_b64_tr_b16 v[82:83], v18 offset:4608
    v_mfma_f32_16x16x32_bf16 v[64:67], v[72:75], v[96:99], v[64:67]
    ds_read_b64_tr_b16 v[84:85], v19 offset:4096
    v_mfma_f32_16x16x32_bf16 v[68:71], v[76:79], v[96:99], v[68:71]
    ds_read_b64_tr_b16 v[86:87], v19 offset:4608
    s_barrier
    v_add_u32 v16, 0x5000, v16
    v_add_u32 v17, 0x5000, v17
    v_add_u32 v18, 0x5000, v18
    v_add_u32 v19, 0x5000, v19
    s_waitcnt lgkmcnt(0)
    v_mfma_f32_16x16x32_bf16 v[48:51], v[80:83], v[100:103], v[48:51]
    ds_read_b128 v[88:91], v16 offset:0
    ds_read_b128 v[92:95], v16 offset:2048
    v_mfma_f32_16x16x32_bf16 v[52:55], v[84:87], v[100:103], v[52:55]
    ds_read_b128 v[96:99], v16 offset:4096
    v_mfma_f32_16x16x32_bf16 v[56:59], v[80:83], v[104:107], v[56:59]
    ds_read_b64_tr_b16 v[72:73], v18 offset:0
    v_mfma_f32_16x16x32_bf16 v[60:63], v[84:87], v[104:107], v[60:63]
    ds_read_b64_tr_b16 v[74:75], v18 offset:512
    v_mfma_f32_16x16x32_bf16 v[64:67], v[80:83], v[108:111], v[64:67]
    ds_read_b64_tr_b16 v[76:77], v19 offset:0
    v_mfma_f32_16x16x32_bf16 v[68:71], v[84:87], v[108:111], v[68:71]
    ds_read_b64_tr_b16 v[78:79], v19 offset:512
    s_waitcnt lgkmcnt(0)
    v_mfma_f32_16x16x32_bf16 v[48:51], v[72:75], v[88:91], v[48:51]
    ds_read_b128 v[100:103], v17 offset:0
    ds_read_b128 v[104:107], v17 offset:2048
    v_mfma_f32_16x16x32_bf16 v[52:55], v[76:79], v[88:91], v[52:55]
    ds_read_b128 v[108:111], v17 offset:4096
    v_mfma_f32_16x16x32_bf16 v[56:59], v[72:75], v[92:95], v[56:59]
    ds_read_b64_tr_b16 v[80:81], v18 offset:4096
    v_mfma_f32_16x16x32_bf16 v[60:63], v[76:79], v[92:95], v[60:63]
    ds_read_b64_tr_b16 v[82:83], v18 offset:4608
    v_mfma_f32_16x16x32_bf16 v[64:67], v[72:75], v[96:99], v[64:67]
    ds_read_b64_tr_b16 v[84:85], v19 offset:4096
    v_mfma_f32_16x16x32_bf16 v[68:71], v[76:79], v[96:99], v[68:71]
    ds_read_b64_tr_b16 v[86:87], v19 offset:4608
    s_barrier
    v_add_u32 v16, 0x5000, v16
    v_add_u32 v17, 0x5000, v17
    v_add_u32 v18, 0x5000, v18
    v_add_u32 v19, 0x5000, v19
    s_waitcnt lgkmcnt(0)
    v_mfma_f32_16x16x32_bf16 v[48:51], v[80:83], v[100:103], v[48:51]
    ds_read_b128 v[88:91], v16 offset:0
    ds_read_b128 v[92:95], v16 offset:2048
    v_mfma_f32_16x16x32_bf16 v[52:55], v[84:87], v[100:103], v[52:55]
    ds_read_b128 v[96:99], v16 offset:4096
    v_mfma_f32_16x16x32_bf16 v[56:59], v[80:83], v[104:107], v[56:59]
    ds_read_b64_tr_b16 v[72:73], v18 offset:0
    v_mfma_f32_16x16x32_bf16 v[60:63], v[84:87], v[104:107], v[60:63]
    ds_read_b64_tr_b16 v[74:75], v18 offset:512
    v_mfma_f32_16x16x32_bf16 v[64:67], v[80:83], v[108:111], v[64:67]
    ds_read_b64_tr_b16 v[76:77], v19 offset:0
    v_mfma_f32_16x16x32_bf16 v[68:71], v[84:87], v[108:111], v[68:71]
    ds_read_b64_tr_b16 v[78:79], v19 offset:512
    s_waitcnt lgkmcnt(0)
    v_mfma_f32_16x16x32_bf16 v[48:51], v[72:75], v[88:91], v[48:51]
    ds_read_b128 v[100:103], v17 offset:0
    ds_read_b128 v[104:107], v17 offset:2048
    v_mfma_f32_16x16x32_bf16 v[52:55], v[76:79], v[88:91], v[52:55]
    ds_read_b128 v[108:111], v17 offset:4096
    v_mfma_f32_16x16x32_bf16 v[56:59], v[72:75], v[92:95], v[56:59]
    ds_read_b64_tr_b16 v[80:81], v18 offset:4096
    v_mfma_f32_16x16x32_bf16 v[60:63], v[76:79], v[92:95], v[60:63]
    ds_read_b64_tr_b16 v[82:83], v18 offset:4608
    v_mfma_f32_16x16x32_bf16 v[64:67], v[72:75], v[96:99], v[64:67]
    ds_read_b64_tr_b16 v[84:85], v19 offset:4096
    v_mfma_f32_16x16x32_bf16 v[68:71], v[76:79], v[96:99], v[68:71]
    ds_read_b64_tr_b16 v[86:87], v19 offset:4608
    s_barrier
    v_add_u32 v16, 0x5000, v16
    v_add_u32 v17, 0x5000, v17
    v_add_u32 v18, 0x5000, v18
    v_add_u32 v19, 0x5000, v19
    s_waitcnt lgkmcnt(0)
    v_mfma_f32_16x16x32_bf16 v[48:51], v[80:83], v[100:103], v[48:51]
    ds_read_b128 v[88:91], v16 offset:0
    ds_read_b128 v[92:95], v16 offset:2048
    v_mfma_f32_16x16x32_bf16 v[52:55], v[84:87], v[100:103], v[52:55]
    ds_read_b128 v[96:99], v16 offset:4096
    v_mfma_f32_16x16x32_bf16 v[56:59], v[80:83], v[104:107], v[56:59]
    ds_read_b64_tr_b16 v[72:73], v18 offset:0
    v_mfma_f32_16x16x32_bf16 v[60:63], v[84:87], v[104:107], v[60:63]
    ds_read_b64_tr_b16 v[74:75], v18 offset:512
    v_mfma_f32_16x16x32_bf16 v[64:67], v[80:83], v[108:111], v[64:67]
    ds_read_b64_tr_b16 v[76:77], v19 offset:0
    v_mfma_f32_16x16x32_bf16 v[68:71], v[84:87], v[108:111], v[68:71]
    ds_read_b64_tr_b16 v[78:79], v19 offset:512
    s_waitcnt lgkmcnt(0)
    v_mfma_f32_16x16x32_bf16 v[48:51], v[72:75], v[88:91], v[48:51]
    ds_read_b128 v[100:103], v17 offset:0
    ds_read_b128 v[104:107], v17 offset:2048
    v_mfma_f32_16x16x32_bf16 v[52:55], v[76:79], v[88:91], v[52:55]
    ds_read_b128 v[108:111], v17 offset:4096
    v_mfma_f32_16x16x32_bf16 v[56:59], v[72:75], v[92:95], v[56:59]
    ds_read_b64_tr_b16 v[80:81], v18 offset:4096
    v_mfma_f32_16x16x32_bf16 v[60:63], v[76:79], v[92:95], v[60:63]
    ds_read_b64_tr_b16 v[82:83], v18 offset:4608
    v_mfma_f32_16x16x32_bf16 v[64:67], v[72:75], v[96:99], v[64:67]
    ds_read_b64_tr_b16 v[84:85], v19 offset:4096
    v_mfma_f32_16x16x32_bf16 v[68:71], v[76:79], v[96:99], v[68:71]
    ds_read_b64_tr_b16 v[86:87], v19 offset:4608
    s_barrier
    v_add_u32 v16, 0x5000, v16
    v_add_u32 v17, 0x5000, v17
    v_add_u32 v18, 0x5000, v18
    v_add_u32 v19, 0x5000, v19
    s_waitcnt lgkmcnt(0)
    v_mfma_f32_16x16x32_bf16 v[48:51], v[80:83], v[100:103], v[48:51]
    ds_read_b128 v[88:91], v16 offset:0
    ds_read_b128 v[92:95], v16 offset:2048
    v_mfma_f32_16x16x32_bf16 v[52:55], v[84:87], v[100:103], v[52:55]
    ds_read_b128 v[96:99], v16 offset:4096
    v_mfma_f32_16x16x32_bf16 v[56:59], v[80:83], v[104:107], v[56:59]
    ds_read_b64_tr_b16 v[72:73], v18 offset:0
    v_mfma_f32_16x16x32_bf16 v[60:63], v[84:87], v[104:107], v[60:63]
    ds_read_b64_tr_b16 v[74:75], v18 offset:512
    v_mfma_f32_16x16x32_bf16 v[64:67], v[80:83], v[108:111], v[64:67]
    ds_read_b64_tr_b16 v[76:77], v19 offset:0
    v_mfma_f32_16x16x32_bf16 v[68:71], v[84:87], v[108:111], v[68:71]
    ds_read_b64_tr_b16 v[78:79], v19 offset:512
    s_waitcnt lgkmcnt(0)
    v_mfma_f32_16x16x32_bf16 v[48:51], v[72:75], v[88:91], v[48:51]
    ds_read_b128 v[100:103], v17 offset:0
    ds_read_b128 v[104:107], v17 offset:2048
    v_mfma_f32_16x16x32_bf16 v[52:55], v[76:79], v[88:91], v[52:55]
    ds_read_b128 v[108:111], v17 offset:4096
    v_mfma_f32_16x16x32_bf16 v[56:59], v[72:75], v[92:95], v[56:59]
    ds_read_b64_tr_b16 v[80:81], v18 offset:4096
    v_mfma_f32_16x16x32_bf16 v[60:63], v[76:79], v[92:95], v[60:63]
    ds_read_b64_tr_b16 v[82:83], v18 offset:4608
    v_mfma_f32_16x16x32_bf16 v[64:67], v[72:75], v[96:99], v[64:67]
    ds_read_b64_tr_b16 v[84:85], v19 offset:4096
    v_mfma_f32_16x16x32_bf16 v[68:71], v[76:79], v[96:99], v[68:71]
    ds_read_b64_tr_b16 v[86:87], v19 offset:4608
    s_barrier
    v_add_u32 v16, 0x5000, v16
    v_add_u32 v17, 0x5000, v17
    v_add_u32 v18, 0x5000, v18
    v_add_u32 v19, 0x5000, v19
    s_waitcnt lgkmcnt(0)
    v_mfma_f32_16x16x32_bf16 v[48:51], v[80:83], v[100:103], v[48:51]
    ds_read_b128 v[88:91], v16 offset:0
    ds_read_b128 v[92:95], v16 offset:2048
    v_mfma_f32_16x16x32_bf16 v[52:55], v[84:87], v[100:103], v[52:55]
    ds_read_b128 v[96:99], v16 offset:4096
    v_mfma_f32_16x16x32_bf16 v[56:59], v[80:83], v[104:107], v[56:59]
    ds_read_b64_tr_b16 v[72:73], v18 offset:0
    v_mfma_f32_16x16x32_bf16 v[60:63], v[84:87], v[104:107], v[60:63]
    ds_read_b64_tr_b16 v[74:75], v18 offset:512
    v_mfma_f32_16x16x32_bf16 v[64:67], v[80:83], v[108:111], v[64:67]
    ds_read_b64_tr_b16 v[76:77], v19 offset:0
    v_mfma_f32_16x16x32_bf16 v[68:71], v[84:87], v[108:111], v[68:71]
    ds_read_b64_tr_b16 v[78:79], v19 offset:512
    s_waitcnt lgkmcnt(0)
    v_mfma_f32_16x16x32_bf16 v[48:51], v[72:75], v[88:91], v[48:51]
    ds_read_b128 v[100:103], v17 offset:0
    ds_read_b128 v[104:107], v17 offset:2048
    v_mfma_f32_16x16x32_bf16 v[52:55], v[76:79], v[88:91], v[52:55]
    ds_read_b128 v[108:111], v17 offset:4096
    v_mfma_f32_16x16x32_bf16 v[56:59], v[72:75], v[92:95], v[56:59]
    ds_read_b64_tr_b16 v[80:81], v18 offset:4096
    v_mfma_f32_16x16x32_bf16 v[60:63], v[76:79], v[92:95], v[60:63]
    ds_read_b64_tr_b16 v[82:83], v18 offset:4608
    v_mfma_f32_16x16x32_bf16 v[64:67], v[72:75], v[96:99], v[64:67]
    ds_read_b64_tr_b16 v[84:85], v19 offset:4096
    v_mfma_f32_16x16x32_bf16 v[68:71], v[76:79], v[96:99], v[68:71]
    ds_read_b64_tr_b16 v[86:87], v19 offset:4608
    s_barrier
    v_add_u32 v16, 0x5000, v16
    v_add_u32 v17, 0x5000, v17
    v_add_u32 v18, 0x5000, v18
    v_add_u32 v19, 0x5000, v19
    s_waitcnt lgkmcnt(0)
    v_mfma_f32_16x16x32_bf16 v[48:51], v[80:83], v[100:103], v[48:51]
    ds_read_b128 v[88:91], v16 offset:0
    ds_read_b128 v[92:95], v16 offset:2048
    v_mfma_f32_16x16x32_bf16 v[52:55], v[84:87], v[100:103], v[52:55]
    ds_read_b128 v[96:99], v16 offset:4096
    v_mfma_f32_16x16x32_bf16 v[56:59], v[80:83], v[104:107], v[56:59]
    ds_read_b64_tr_b16 v[72:73], v18 offset:0
    v_mfma_f32_16x16x32_bf16 v[60:63], v[84:87], v[104:107], v[60:63]
    ds_read_b64_tr_b16 v[74:75], v18 offset:512
    v_mfma_f32_16x16x32_bf16 v[64:67], v[80:83], v[108:111], v[64:67]
    ds_read_b64_tr_b16 v[76:77], v19 offset:0
    v_mfma_f32_16x16x32_bf16 v[68:71], v[84:87], v[108:111], v[68:71]
    ds_read_b64_tr_b16 v[78:79], v19 offset:512
    s_waitcnt lgkmcnt(0)
    v_mfma_f32_16x16x32_bf16 v[48:51], v[72:75], v[88:91], v[48:51]
    ds_read_b128 v[100:103], v17 offset:0
    ds_read_b128 v[104:107], v17 offset:2048
    v_mfma_f32_16x16x32_bf16 v[52:55], v[76:79], v[88:91], v[52:55]
    ds_read_b128 v[108:111], v17 offset:4096
    v_mfma_f32_16x16x32_bf16 v[56:59], v[72:75], v[92:95], v[56:59]
    ds_read_b64_tr_b16 v[80:81], v18 offset:4096
    v_mfma_f32_16x16x32_bf16 v[60:63], v[76:79], v[92:95], v[60:63]
    ds_read_b64_tr_b16 v[82:83], v18 offset:4608
    v_mfma_f32_16x16x32_bf16 v[64:67], v[72:75], v[96:99], v[64:67]
    ds_read_b64_tr_b16 v[84:85], v19 offset:4096
    v_mfma_f32_16x16x32_bf16 v[68:71], v[76:79], v[96:99], v[68:71]
    ds_read_b64_tr_b16 v[86:87], v19 offset:4608
    s_barrier
    v_add_u32 v16, 0x5000, v16
    v_add_u32 v17, 0x5000, v17
    v_add_u32 v18, 0x5000, v18
    v_add_u32 v19, 0x5000, v19
    s_waitcnt lgkmcnt(0)
    v_mfma_f32_16x16x32_bf16 v[48:51], v[80:83], v[100:103], v[48:51]
    ds_read_b128 v[88:91], v16 offset:0
    ds_read_b128 v[92:95], v16 offset:2048
    v_mfma_f32_16x16x32_bf16 v[52:55], v[84:87], v[100:103], v[52:55]
    ds_read_b128 v[96:99], v16 offset:4096
    v_mfma_f32_16x16x32_bf16 v[56:59], v[80:83], v[104:107], v[56:59]
    ds_read_b64_tr_b16 v[72:73], v18 offset:0
    v_mfma_f32_16x16x32_bf16 v[60:63], v[84:87], v[104:107], v[60:63]
    ds_read_b64_tr_b16 v[74:75], v18 offset:512
    v_mfma_f32_16x16x32_bf16 v[64:67], v[80:83], v[108:111], v[64:67]
    ds_read_b64_tr_b16 v[76:77], v19 offset:0
    v_mfma_f32_16x16x32_bf16 v[68:71], v[84:87], v[108:111], v[68:71]
    ds_read_b64_tr_b16 v[78:79], v19 offset:512
    s_waitcnt lgkmcnt(0)
    v_mfma_f32_16x16x32_bf16 v[48:51], v[72:75], v[88:91], v[48:51]
    ds_read_b128 v[100:103], v17 offset:0
    ds_read_b128 v[104:107], v17 offset:2048
    v_mfma_f32_16x16x32_bf16 v[52:55], v[76:79], v[88:91], v[52:55]
    ds_read_b128 v[108:111], v17 offset:4096
    v_mfma_f32_16x16x32_bf16 v[56:59], v[72:75], v[92:95], v[56:59]
    ds_read_b64_tr_b16 v[80:81], v18 offset:4096
    v_mfma_f32_16x16x32_bf16 v[60:63], v[76:79], v[92:95], v[60:63]
    ds_read_b64_tr_b16 v[82:83], v18 offset:4608
    v_mfma_f32_16x16x32_bf16 v[64:67], v[72:75], v[96:99], v[64:67]
    ds_read_b64_tr_b16 v[84:85], v19 offset:4096
    v_mfma_f32_16x16x32_bf16 v[68:71], v[76:79], v[96:99], v[68:71]
    ds_read_b64_tr_b16 v[86:87], v19 offset:4608
    s_barrier
    v_add_u32 v16, 0xfffdd000, v16
    v_add_u32 v17, 0xfffdd000, v17
    v_add_u32 v18, 0xfffdd000, v18
    v_add_u32 v19, 0xfffdd000, v19
    s_waitcnt lgkmcnt(0)
    v_mfma_f32_16x16x32_bf16 v[48:51], v[80:83], v[100:103], v[48:51]
    ds_read_b128 v[88:91], v16 offset:0
    ds_read_b128 v[92:95], v16 offset:2048
    v_mfma_f32_16x16x32_bf16 v[52:55], v[84:87], v[100:103], v[52:55]
    ds_read_b128 v[96:99], v16 offset:4096
    v_mfma_f32_16x16x32_bf16 v[56:59], v[80:83], v[104:107], v[56:59]
    ds_read_b64_tr_b16 v[72:73], v18 offset:0
    v_mfma_f32_16x16x32_bf16 v[60:63], v[84:87], v[104:107], v[60:63]
    ds_read_b64_tr_b16 v[74:75], v18 offset:512
    v_mfma_f32_16x16x32_bf16 v[64:67], v[80:83], v[108:111], v[64:67]
    ds_read_b64_tr_b16 v[76:77], v19 offset:0
    v_mfma_f32_16x16x32_bf16 v[68:71], v[84:87], v[108:111], v[68:71]
    ds_read_b64_tr_b16 v[78:79], v19 offset:512
    s_waitcnt lgkmcnt(0)
    v_mfma_f32_16x16x32_bf16 v[48:51], v[72:75], v[88:91], v[48:51]
    ds_read_b128 v[100:103], v17 offset:0
    ds_read_b128 v[104:107], v17 offset:2048
    v_mfma_f32_16x16x32_bf16 v[52:55], v[76:79], v[88:91], v[52:55]
    ds_read_b128 v[108:111], v17 offset:4096
    v_mfma_f32_16x16x32_bf16 v[56:59], v[72:75], v[92:95], v[56:59]
    ds_read_b64_tr_b16 v[80:81], v18 offset:4096
    v_mfma_f32_16x16x32_bf16 v[60:63], v[76:79], v[92:95], v[60:63]
    ds_read_b64_tr_b16 v[82:83], v18 offset:4608
    v_mfma_f32_16x16x32_bf16 v[64:67], v[72:75], v[96:99], v[64:67]
    ds_read_b64_tr_b16 v[84:85], v19 offset:4096
    v_mfma_f32_16x16x32_bf16 v[68:71], v[76:79], v[96:99], v[68:71]
    ds_read_b64_tr_b16 v[86:87], v19 offset:4608
    s_barrier
    v_add_u32 v16, 0x5000, v16
    v_add_u32 v17, 0x5000, v17
    v_add_u32 v18, 0x5000, v18
    v_add_u32 v19, 0x5000, v19
    s_waitcnt lgkmcnt(0)
    v_mfma_f32_16x16x32_bf16 v[48:51], v[80:83], v[100:103], v[48:51]
    ds_read_b128 v[88:91], v16 offset:0
    ds_read_b128 v[92:95], v16 offset:2048
    v_mfma_f32_16x16x32_bf16 v[52:55], v[84:87], v[100:103], v[52:55]
    ds_read_b128 v[96:99], v16 offset:4096
    v_mfma_f32_16x16x32_bf16 v[56:59], v[80:83], v[104:107], v[56:59]
    ds_read_b64_tr_b16 v[72:73], v18 offset:0
    v_mfma_f32_16x16x32_bf16 v[60:63], v[84:87], v[104:107], v[60:63]
    ds_read_b64_tr_b16 v[74:75], v18 offset:512
    v_mfma_f32_16x16x32_bf16 v[64:67], v[80:83], v[108:111], v[64:67]
    ds_read_b64_tr_b16 v[76:77], v19 offset:0
    v_mfma_f32_16x16x32_bf16 v[68:71], v[84:87], v[108:111], v[68:71]
    ds_read_b64_tr_b16 v[78:79], v19 offset:512
    s_waitcnt lgkmcnt(0)
    v_mfma_f32_16x16x32_bf16 v[48:51], v[72:75], v[88:91], v[48:51]
    ds_read_b128 v[100:103], v17 offset:0
    ds_read_b128 v[104:107], v17 offset:2048
    v_mfma_f32_16x16x32_bf16 v[52:55], v[76:79], v[88:91], v[52:55]
    ds_read_b128 v[108:111], v17 offset:4096
    v_mfma_f32_16x16x32_bf16 v[56:59], v[72:75], v[92:95], v[56:59]
    ds_read_b64_tr_b16 v[80:81], v18 offset:4096
    v_mfma_f32_16x16x32_bf16 v[60:63], v[76:79], v[92:95], v[60:63]
    ds_read_b64_tr_b16 v[82:83], v18 offset:4608
    v_mfma_f32_16x16x32_bf16 v[64:67], v[72:75], v[96:99], v[64:67]
    ds_read_b64_tr_b16 v[84:85], v19 offset:4096
    v_mfma_f32_16x16x32_bf16 v[68:71], v[76:79], v[96:99], v[68:71]
    ds_read_b64_tr_b16 v[86:87], v19 offset:4608
    s_barrier
    v_add_u32 v16, 0x5000, v16
    v_add_u32 v17, 0x5000, v17
    v_add_u32 v18, 0x5000, v18
    v_add_u32 v19, 0x5000, v19
    s_waitcnt lgkmcnt(0)
    v_mfma_f32_16x16x32_bf16 v[48:51], v[80:83], v[100:103], v[48:51]
    ds_read_b128 v[88:91], v16 offset:0
    ds_read_b128 v[92:95], v16 offset:2048
    v_mfma_f32_16x16x32_bf16 v[52:55], v[84:87], v[100:103], v[52:55]
    ds_read_b128 v[96:99], v16 offset:4096
    v_mfma_f32_16x16x32_bf16 v[56:59], v[80:83], v[104:107], v[56:59]
    ds_read_b64_tr_b16 v[72:73], v18 offset:0
    v_mfma_f32_16x16x32_bf16 v[60:63], v[84:87], v[104:107], v[60:63]
    ds_read_b64_tr_b16 v[74:75], v18 offset:512
    v_mfma_f32_16x16x32_bf16 v[64:67], v[80:83], v[108:111], v[64:67]
    ds_read_b64_tr_b16 v[76:77], v19 offset:0
    v_mfma_f32_16x16x32_bf16 v[68:71], v[84:87], v[108:111], v[68:71]
    ds_read_b64_tr_b16 v[78:79], v19 offset:512
    s_waitcnt lgkmcnt(0)
    v_mfma_f32_16x16x32_bf16 v[48:51], v[72:75], v[88:91], v[48:51]
    ds_read_b128 v[100:103], v17 offset:0
    ds_read_b128 v[104:107], v17 offset:2048
    v_mfma_f32_16x16x32_bf16 v[52:55], v[76:79], v[88:91], v[52:55]
    ds_read_b128 v[108:111], v17 offset:4096
    v_mfma_f32_16x16x32_bf16 v[56:59], v[72:75], v[92:95], v[56:59]
    ds_read_b64_tr_b16 v[80:81], v18 offset:4096
    v_mfma_f32_16x16x32_bf16 v[60:63], v[76:79], v[92:95], v[60:63]
    ds_read_b64_tr_b16 v[82:83], v18 offset:4608
    v_mfma_f32_16x16x32_bf16 v[64:67], v[72:75], v[96:99], v[64:67]
    ds_read_b64_tr_b16 v[84:85], v19 offset:4096
    v_mfma_f32_16x16x32_bf16 v[68:71], v[76:79], v[96:99], v[68:71]
    ds_read_b64_tr_b16 v[86:87], v19 offset:4608
    s_barrier
    v_add_u32 v16, 0x5000, v16
    v_add_u32 v17, 0x5000, v17
    v_add_u32 v18, 0x5000, v18
    v_add_u32 v19, 0x5000, v19
    s_waitcnt lgkmcnt(0)
    v_mfma_f32_16x16x32_bf16 v[48:51], v[80:83], v[100:103], v[48:51]
    ds_read_b128 v[88:91], v16 offset:0
    ds_read_b128 v[92:95], v16 offset:2048
    v_mfma_f32_16x16x32_bf16 v[52:55], v[84:87], v[100:103], v[52:55]
    ds_read_b128 v[96:99], v16 offset:4096
    v_mfma_f32_16x16x32_bf16 v[56:59], v[80:83], v[104:107], v[56:59]
    ds_read_b64_tr_b16 v[72:73], v18 offset:0
    v_mfma_f32_16x16x32_bf16 v[60:63], v[84:87], v[104:107], v[60:63]
    ds_read_b64_tr_b16 v[74:75], v18 offset:512
    v_mfma_f32_16x16x32_bf16 v[64:67], v[80:83], v[108:111], v[64:67]
    ds_read_b64_tr_b16 v[76:77], v19 offset:0
    v_mfma_f32_16x16x32_bf16 v[68:71], v[84:87], v[108:111], v[68:71]
    ds_read_b64_tr_b16 v[78:79], v19 offset:512
    s_waitcnt lgkmcnt(0)
    v_mfma_f32_16x16x32_bf16 v[48:51], v[72:75], v[88:91], v[48:51]
    ds_read_b128 v[100:103], v17 offset:0
    ds_read_b128 v[104:107], v17 offset:2048
    v_mfma_f32_16x16x32_bf16 v[52:55], v[76:79], v[88:91], v[52:55]
    ds_read_b128 v[108:111], v17 offset:4096
    v_mfma_f32_16x16x32_bf16 v[56:59], v[72:75], v[92:95], v[56:59]
    ds_read_b64_tr_b16 v[80:81], v18 offset:4096
    v_mfma_f32_16x16x32_bf16 v[60:63], v[76:79], v[92:95], v[60:63]
    ds_read_b64_tr_b16 v[82:83], v18 offset:4608
    v_mfma_f32_16x16x32_bf16 v[64:67], v[72:75], v[96:99], v[64:67]
    ds_read_b64_tr_b16 v[84:85], v19 offset:4096
    v_mfma_f32_16x16x32_bf16 v[68:71], v[76:79], v[96:99], v[68:71]
    ds_read_b64_tr_b16 v[86:87], v19 offset:4608
    s_barrier
    v_add_u32 v16, 0x5000, v16
    v_add_u32 v17, 0x5000, v17
    v_add_u32 v18, 0x5000, v18
    v_add_u32 v19, 0x5000, v19
    s_waitcnt lgkmcnt(0)
    v_mfma_f32_16x16x32_bf16 v[48:51], v[80:83], v[100:103], v[48:51]
    ds_read_b128 v[88:91], v16 offset:0
    ds_read_b128 v[92:95], v16 offset:2048
    v_mfma_f32_16x16x32_bf16 v[52:55], v[84:87], v[100:103], v[52:55]
    ds_read_b128 v[96:99], v16 offset:4096
    v_mfma_f32_16x16x32_bf16 v[56:59], v[80:83], v[104:107], v[56:59]
    ds_read_b64_tr_b16 v[72:73], v18 offset:0
    v_mfma_f32_16x16x32_bf16 v[60:63], v[84:87], v[104:107], v[60:63]
    ds_read_b64_tr_b16 v[74:75], v18 offset:512
    v_mfma_f32_16x16x32_bf16 v[64:67], v[80:83], v[108:111], v[64:67]
    ds_read_b64_tr_b16 v[76:77], v19 offset:0
    v_mfma_f32_16x16x32_bf16 v[68:71], v[84:87], v[108:111], v[68:71]
    ds_read_b64_tr_b16 v[78:79], v19 offset:512
    s_waitcnt lgkmcnt(0)
    v_mfma_f32_16x16x32_bf16 v[48:51], v[72:75], v[88:91], v[48:51]
    ds_read_b128 v[100:103], v17 offset:0
    ds_read_b128 v[104:107], v17 offset:2048
    v_mfma_f32_16x16x32_bf16 v[52:55], v[76:79], v[88:91], v[52:55]
    ds_read_b128 v[108:111], v17 offset:4096
    v_mfma_f32_16x16x32_bf16 v[56:59], v[72:75], v[92:95], v[56:59]
    ds_read_b64_tr_b16 v[80:81], v18 offset:4096
    v_mfma_f32_16x16x32_bf16 v[60:63], v[76:79], v[92:95], v[60:63]
    ds_read_b64_tr_b16 v[82:83], v18 offset:4608
    v_mfma_f32_16x16x32_bf16 v[64:67], v[72:75], v[96:99], v[64:67]
    ds_read_b64_tr_b16 v[84:85], v19 offset:4096
    v_mfma_f32_16x16x32_bf16 v[68:71], v[76:79], v[96:99], v[68:71]
    ds_read_b64_tr_b16 v[86:87], v19 offset:4608
    s_barrier
    v_add_u32 v16, 0x5000, v16
    v_add_u32 v17, 0x5000, v17
    v_add_u32 v18, 0x5000, v18
    v_add_u32 v19, 0x5000, v19
    s_waitcnt lgkmcnt(0)
    v_mfma_f32_16x16x32_bf16 v[48:51], v[80:83], v[100:103], v[48:51]
    ds_read_b128 v[88:91], v16 offset:0
    ds_read_b128 v[92:95], v16 offset:2048
    v_mfma_f32_16x16x32_bf16 v[52:55], v[84:87], v[100:103], v[52:55]
    ds_read_b128 v[96:99], v16 offset:4096
    v_mfma_f32_16x16x32_bf16 v[56:59], v[80:83], v[104:107], v[56:59]
    ds_read_b64_tr_b16 v[72:73], v18 offset:0
    v_mfma_f32_16x16x32_bf16 v[60:63], v[84:87], v[104:107], v[60:63]
    ds_read_b64_tr_b16 v[74:75], v18 offset:512
    v_mfma_f32_16x16x32_bf16 v[64:67], v[80:83], v[108:111], v[64:67]
    ds_read_b64_tr_b16 v[76:77], v19 offset:0
    v_mfma_f32_16x16x32_bf16 v[68:71], v[84:87], v[108:111], v[68:71]
    ds_read_b64_tr_b16 v[78:79], v19 offset:512
    s_waitcnt lgkmcnt(0)
    v_mfma_f32_16x16x32_bf16 v[48:51], v[72:75], v[88:91], v[48:51]
    ds_read_b128 v[100:103], v17 offset:0
    ds_read_b128 v[104:107], v17 offset:2048
    v_mfma_f32_16x16x32_bf16 v[52:55], v[76:79], v[88:91], v[52:55]
    ds_read_b128 v[108:111], v17 offset:4096
    v_mfma_f32_16x16x32_bf16 v[56:59], v[72:75], v[92:95], v[56:59]
    ds_read_b64_tr_b16 v[80:81], v18 offset:4096
    v_mfma_f32_16x16x32_bf16 v[60:63], v[76:79], v[92:95], v[60:63]
    ds_read_b64_tr_b16 v[82:83], v18 offset:4608
    v_mfma_f32_16x16x32_bf16 v[64:67], v[72:75], v[96:99], v[64:67]
    ds_read_b64_tr_b16 v[84:85], v19 offset:4096
    v_mfma_f32_16x16x32_bf16 v[68:71], v[76:79], v[96:99], v[68:71]
    ds_read_b64_tr_b16 v[86:87], v19 offset:4608
    s_barrier
    v_add_u32 v16, 0x5000, v16
    v_add_u32 v17, 0x5000, v17
    v_add_u32 v18, 0x5000, v18
    v_add_u32 v19, 0x5000, v19
    s_waitcnt lgkmcnt(0)
    v_mfma_f32_16x16x32_bf16 v[48:51], v[80:83], v[100:103], v[48:51]
    ds_read_b128 v[88:91], v16 offset:0
    ds_read_b128 v[92:95], v16 offset:2048
    v_mfma_f32_16x16x32_bf16 v[52:55], v[84:87], v[100:103], v[52:55]
    ds_read_b128 v[96:99], v16 offset:4096
    v_mfma_f32_16x16x32_bf16 v[56:59], v[80:83], v[104:107], v[56:59]
    ds_read_b64_tr_b16 v[72:73], v18 offset:0
    v_mfma_f32_16x16x32_bf16 v[60:63], v[84:87], v[104:107], v[60:63]
    ds_read_b64_tr_b16 v[74:75], v18 offset:512
    v_mfma_f32_16x16x32_bf16 v[64:67], v[80:83], v[108:111], v[64:67]
    ds_read_b64_tr_b16 v[76:77], v19 offset:0
    v_mfma_f32_16x16x32_bf16 v[68:71], v[84:87], v[108:111], v[68:71]
    ds_read_b64_tr_b16 v[78:79], v19 offset:512
    s_waitcnt lgkmcnt(0)
    v_mfma_f32_16x16x32_bf16 v[48:51], v[72:75], v[88:91], v[48:51]
    ds_read_b128 v[100:103], v17 offset:0
    ds_read_b128 v[104:107], v17 offset:2048
    v_mfma_f32_16x16x32_bf16 v[52:55], v[76:79], v[88:91], v[52:55]
    ds_read_b128 v[108:111], v17 offset:4096
    v_mfma_f32_16x16x32_bf16 v[56:59], v[72:75], v[92:95], v[56:59]
    ds_read_b64_tr_b16 v[80:81], v18 offset:4096
    v_mfma_f32_16x16x32_bf16 v[60:63], v[76:79], v[92:95], v[60:63]
    ds_read_b64_tr_b16 v[82:83], v18 offset:4608
    v_mfma_f32_16x16x32_bf16 v[64:67], v[72:75], v[96:99], v[64:67]
    ds_read_b64_tr_b16 v[84:85], v19 offset:4096
    v_mfma_f32_16x16x32_bf16 v[68:71], v[76:79], v[96:99], v[68:71]
    ds_read_b64_tr_b16 v[86:87], v19 offset:4608
    s_barrier
    v_add_u32 v16, 0x5000, v16
    v_add_u32 v17, 0x5000, v17
    v_add_u32 v18, 0x5000, v18
    v_add_u32 v19, 0x5000, v19
    s_waitcnt lgkmcnt(0)
    v_mfma_f32_16x16x32_bf16 v[48:51], v[80:83], v[100:103], v[48:51]
    ds_read_b128 v[88:91], v16 offset:0
    ds_read_b128 v[92:95], v16 offset:2048
    v_mfma_f32_16x16x32_bf16 v[52:55], v[84:87], v[100:103], v[52:55]
    ds_read_b128 v[96:99], v16 offset:4096
    v_mfma_f32_16x16x32_bf16 v[56:59], v[80:83], v[104:107], v[56:59]
    ds_read_b64_tr_b16 v[72:73], v18 offset:0
    v_mfma_f32_16x16x32_bf16 v[60:63], v[84:87], v[104:107], v[60:63]
    ds_read_b64_tr_b16 v[74:75], v18 offset:512
    v_mfma_f32_16x16x32_bf16 v[64:67], v[80:83], v[108:111], v[64:67]
    ds_read_b64_tr_b16 v[76:77], v19 offset:0
    v_mfma_f32_16x16x32_bf16 v[68:71], v[84:87], v[108:111], v[68:71]
    ds_read_b64_tr_b16 v[78:79], v19 offset:512
    s_waitcnt lgkmcnt(0)
    v_mfma_f32_16x16x32_bf16 v[48:51], v[72:75], v[88:91], v[48:51]
    ds_read_b128 v[100:103], v17 offset:0
    ds_read_b128 v[104:107], v17 offset:2048
    v_mfma_f32_16x16x32_bf16 v[52:55], v[76:79], v[88:91], v[52:55]
    ds_read_b128 v[108:111], v17 offset:4096
    v_mfma_f32_16x16x32_bf16 v[56:59], v[72:75], v[92:95], v[56:59]
    ds_read_b64_tr_b16 v[80:81], v18 offset:4096
    v_mfma_f32_16x16x32_bf16 v[60:63], v[76:79], v[92:95], v[60:63]
    ds_read_b64_tr_b16 v[82:83], v18 offset:4608
    v_mfma_f32_16x16x32_bf16 v[64:67], v[72:75], v[96:99], v[64:67]
    ds_read_b64_tr_b16 v[84:85], v19 offset:4096
    v_mfma_f32_16x16x32_bf16 v[68:71], v[76:79], v[96:99], v[68:71]
    ds_read_b64_tr_b16 v[86:87], v19 offset:4608
    s_barrier
    v_add_u32 v16, 0xfffdd000, v16
    v_add_u32 v17, 0xfffdd000, v17
    v_add_u32 v18, 0xfffdd000, v18
    v_add_u32 v19, 0xfffdd000, v19
    s_waitcnt lgkmcnt(0)
    v_mfma_f32_16x16x32_bf16 v[48:51], v[80:83], v[100:103], v[48:51]
    ds_read_b128 v[88:91], v16 offset:0
    ds_read_b128 v[92:95], v16 offset:2048
    v_mfma_f32_16x16x32_bf16 v[52:55], v[84:87], v[100:103], v[52:55]
    ds_read_b128 v[96:99], v16 offset:4096
    v_mfma_f32_16x16x32_bf16 v[56:59], v[80:83], v[104:107], v[56:59]
    ds_read_b64_tr_b16 v[72:73], v18 offset:0
    v_mfma_f32_16x16x32_bf16 v[60:63], v[84:87], v[104:107], v[60:63]
    ds_read_b64_tr_b16 v[74:75], v18 offset:512
    v_mfma_f32_16x16x32_bf16 v[64:67], v[80:83], v[108:111], v[64:67]
    ds_read_b64_tr_b16 v[76:77], v19 offset:0
    v_mfma_f32_16x16x32_bf16 v[68:71], v[84:87], v[108:111], v[68:71]
    ds_read_b64_tr_b16 v[78:79], v19 offset:512
    s_waitcnt lgkmcnt(0)
    v_mfma_f32_16x16x32_bf16 v[48:51], v[72:75], v[88:91], v[48:51]
    ds_read_b128 v[100:103], v17 offset:0
    ds_read_b128 v[104:107], v17 offset:2048
    v_mfma_f32_16x16x32_bf16 v[52:55], v[76:79], v[88:91], v[52:55]
    ds_read_b128 v[108:111], v17 offset:4096
    v_mfma_f32_16x16x32_bf16 v[56:59], v[72:75], v[92:95], v[56:59]
    ds_read_b64_tr_b16 v[80:81], v18 offset:4096
    v_mfma_f32_16x16x32_bf16 v[60:63], v[76:79], v[92:95], v[60:63]
    ds_read_b64_tr_b16 v[82:83], v18 offset:4608
    v_mfma_f32_16x16x32_bf16 v[64:67], v[72:75], v[96:99], v[64:67]
    ds_read_b64_tr_b16 v[84:85], v19 offset:4096
    v_mfma_f32_16x16x32_bf16 v[68:71], v[76:79], v[96:99], v[68:71]
    ds_read_b64_tr_b16 v[86:87], v19 offset:4608
    s_barrier
    v_add_u32 v16, 0x5000, v16
    v_add_u32 v17, 0x5000, v17
    v_add_u32 v18, 0x5000, v18
    v_add_u32 v19, 0x5000, v19
    s_waitcnt lgkmcnt(0)
    v_mfma_f32_16x16x32_bf16 v[48:51], v[80:83], v[100:103], v[48:51]
    ds_read_b128 v[88:91], v16 offset:0
    ds_read_b128 v[92:95], v16 offset:2048
    v_mfma_f32_16x16x32_bf16 v[52:55], v[84:87], v[100:103], v[52:55]
    ds_read_b128 v[96:99], v16 offset:4096
    v_mfma_f32_16x16x32_bf16 v[56:59], v[80:83], v[104:107], v[56:59]
    ds_read_b64_tr_b16 v[72:73], v18 offset:0
    v_mfma_f32_16x16x32_bf16 v[60:63], v[84:87], v[104:107], v[60:63]
    ds_read_b64_tr_b16 v[74:75], v18 offset:512
    v_mfma_f32_16x16x32_bf16 v[64:67], v[80:83], v[108:111], v[64:67]
    ds_read_b64_tr_b16 v[76:77], v19 offset:0
    v_mfma_f32_16x16x32_bf16 v[68:71], v[84:87], v[108:111], v[68:71]
    ds_read_b64_tr_b16 v[78:79], v19 offset:512
    s_waitcnt lgkmcnt(0)
    v_mfma_f32_16x16x32_bf16 v[48:51], v[72:75], v[88:91], v[48:51]
    ds_read_b128 v[100:103], v17 offset:0
    ds_read_b128 v[104:107], v17 offset:2048
    v_mfma_f32_16x16x32_bf16 v[52:55], v[76:79], v[88:91], v[52:55]
    ds_read_b128 v[108:111], v17 offset:4096
    v_mfma_f32_16x16x32_bf16 v[56:59], v[72:75], v[92:95], v[56:59]
    ds_read_b64_tr_b16 v[80:81], v18 offset:4096
    v_mfma_f32_16x16x32_bf16 v[60:63], v[76:79], v[92:95], v[60:63]
    ds_read_b64_tr_b16 v[82:83], v18 offset:4608
    v_mfma_f32_16x16x32_bf16 v[64:67], v[72:75], v[96:99], v[64:67]
    ds_read_b64_tr_b16 v[84:85], v19 offset:4096
    v_mfma_f32_16x16x32_bf16 v[68:71], v[76:79], v[96:99], v[68:71]
    ds_read_b64_tr_b16 v[86:87], v19 offset:4608
    s_barrier
    v_add_u32 v16, 0x5000, v16
    v_add_u32 v17, 0x5000, v17
    v_add_u32 v18, 0x5000, v18
    v_add_u32 v19, 0x5000, v19
    s_waitcnt lgkmcnt(0)
    v_mfma_f32_16x16x32_bf16 v[48:51], v[80:83], v[100:103], v[48:51]
    ds_read_b128 v[88:91], v16 offset:0
    ds_read_b128 v[92:95], v16 offset:2048
    v_mfma_f32_16x16x32_bf16 v[52:55], v[84:87], v[100:103], v[52:55]
    ds_read_b128 v[96:99], v16 offset:4096
    v_mfma_f32_16x16x32_bf16 v[56:59], v[80:83], v[104:107], v[56:59]
    ds_read_b64_tr_b16 v[72:73], v18 offset:0
    v_mfma_f32_16x16x32_bf16 v[60:63], v[84:87], v[104:107], v[60:63]
    ds_read_b64_tr_b16 v[74:75], v18 offset:512
    v_mfma_f32_16x16x32_bf16 v[64:67], v[80:83], v[108:111], v[64:67]
    ds_read_b64_tr_b16 v[76:77], v19 offset:0
    v_mfma_f32_16x16x32_bf16 v[68:71], v[84:87], v[108:111], v[68:71]
    ds_read_b64_tr_b16 v[78:79], v19 offset:512
    s_waitcnt lgkmcnt(0)
    v_mfma_f32_16x16x32_bf16 v[48:51], v[72:75], v[88:91], v[48:51]
    ds_read_b128 v[100:103], v17 offset:0
    ds_read_b128 v[104:107], v17 offset:2048
    v_mfma_f32_16x16x32_bf16 v[52:55], v[76:79], v[88:91], v[52:55]
    ds_read_b128 v[108:111], v17 offset:4096
    v_mfma_f32_16x16x32_bf16 v[56:59], v[72:75], v[92:95], v[56:59]
    ds_read_b64_tr_b16 v[80:81], v18 offset:4096
    v_mfma_f32_16x16x32_bf16 v[60:63], v[76:79], v[92:95], v[60:63]
    ds_read_b64_tr_b16 v[82:83], v18 offset:4608
    v_mfma_f32_16x16x32_bf16 v[64:67], v[72:75], v[96:99], v[64:67]
    ds_read_b64_tr_b16 v[84:85], v19 offset:4096
    v_mfma_f32_16x16x32_bf16 v[68:71], v[76:79], v[96:99], v[68:71]
    ds_read_b64_tr_b16 v[86:87], v19 offset:4608
    s_waitcnt lgkmcnt(0)
    v_mfma_f32_16x16x32_bf16 v[48:51], v[80:83], v[100:103], v[48:51]
    v_mfma_f32_16x16x32_bf16 v[52:55], v[84:87], v[100:103], v[52:55]
    v_mfma_f32_16x16x32_bf16 v[56:59], v[80:83], v[104:107], v[56:59]
    v_mfma_f32_16x16x32_bf16 v[60:63], v[84:87], v[104:107], v[60:63]
    v_mfma_f32_16x16x32_bf16 v[64:67], v[80:83], v[108:111], v[64:67]
    v_mfma_f32_16x16x32_bf16 v[68:71], v[84:87], v[108:111], v[68:71]
    s_barrier
    s_nop 7
    v_cvt_pk_bf16_f32 v48, v48, v49
    v_cvt_pk_bf16_f32 v49, v50, v51
    ds_write_b64 v26, v[48:49] offset:0
    v_cvt_pk_bf16_f32 v56, v56, v57
    v_cvt_pk_bf16_f32 v57, v58, v59
    ds_write_b64 v26, v[56:57] offset:2304
    v_cvt_pk_bf16_f32 v64, v64, v65
    v_cvt_pk_bf16_f32 v65, v66, v67
    ds_write_b64 v26, v[64:65] offset:4608
    v_cvt_pk_bf16_f32 v52, v52, v53
    v_cvt_pk_bf16_f32 v53, v54, v55
    ds_write_b64 v26, v[52:53] offset:32
    v_cvt_pk_bf16_f32 v60, v60, v61
    v_cvt_pk_bf16_f32 v61, v62, v63
    ds_write_b64 v26, v[60:61] offset:2336
    v_cvt_pk_bf16_f32 v68, v68, v69
    v_cvt_pk_bf16_f32 v69, v70, v71
    ds_write_b64 v26, v[68:69] offset:4640
    s_waitcnt lgkmcnt(0)
    s_barrier
    ds_read_b128 v[72:75], v28 offset:0
    ds_read_b128 v[76:79], v28 offset:1152
    ds_read_b128 v[80:83], v28 offset:2304
    s_mov_b32 s28, 0
    s_waitcnt lgkmcnt(2)
    buffer_store_dwordx4 v[72:75], v29, s[16:19], s28 offen
    s_mov_b32 s28, 10240
    s_waitcnt lgkmcnt(1)
    buffer_store_dwordx4 v[76:79], v29, s[16:19], s28 offen
    s_mov_b32 s28, 20480
    s_waitcnt lgkmcnt(0)
    buffer_store_dwordx4 v[80:83], v29, s[16:19], s28 offen
    s_endpgm
L_ffn2_kernel_loader:
    s_and_b32 s20, s32, 3
    s_mov_b32 s25, 3456
    v_mul_u32_u24 v5, 24, v4
    v_lshrrev_b32 v6, 3, v1
    v_add_u32 v5, v5, v6
    v_and_b32 v6, 7, v1
    v_add_u32 v8, 0, v5
    v_bfe_u32 v7, v8, 1, 3
    v_xor_b32 v7, v7, v6
    v_add_u32 v8, s22, v8
    v_mul_lo_u32 v8, v8, s25
    v_lshl_add_u32 v8, v7, 4, v8
    v_add_u32 v9, 8, v5
    v_bfe_u32 v7, v9, 1, 3
    v_xor_b32 v7, v7, v6
    v_add_u32 v9, s22, v9
    v_mul_lo_u32 v9, v9, s25
    v_lshl_add_u32 v9, v7, 4, v9
    v_add_u32 v10, 16, v5
    v_bfe_u32 v7, v10, 1, 3
    v_xor_b32 v7, v7, v6
    v_add_u32 v10, s22, v10
    v_mul_lo_u32 v10, v10, s25
    v_lshl_add_u32 v10, v7, 4, v10
    s_mov_b32 s25, 1280
    v_lshrrev_b32 v5, 3, v1
    v_and_b32 v6, 7, v1
    v_and_b32 v7, 2, v5
    v_xor_b32 v7, v7, v6
    v_lshl_add_u32 v12, v4, 4, v5
    v_add_u32 v12, 0, v12
    v_mul_lo_u32 v12, v12, s25
    v_lshl_add_u32 v7, v7, 4, s24
    v_add_u32 v12, v12, v7
    v_and_b32 v7, 2, v5
    v_xor_b32 v7, v7, v6
    v_xor_b32 v7, 4, v7
    v_lshl_add_u32 v13, v4, 4, v5
    v_add_u32 v13, 8, v13
    v_mul_lo_u32 v13, v13, s25
    v_lshl_add_u32 v7, v7, 4, s24
    v_add_u32 v13, v13, v7
    s_lshl_b32 s21, s20, 11
    s_add_u32 s21, s21, 12288
    s_mul_i32 s20, s20, 3072
    s_waitcnt lgkmcnt(0)
    s_mov_b32 s6, 7077888
    s_mov_b32 s7, 0x00020000
    s_mov_b32 s10, 2211840
    s_mov_b32 s11, 0x00020000
    s_add_u32 m0, s21, 0
    s_nop 0
    buffer_load_dwordx4 v12, s[8:11], s29 offen lds
    s_add_u32 m0, s21, 1024
    s_nop 0
    buffer_load_dwordx4 v13, s[8:11], s29 offen lds
    s_add_u32 m0, s20, 0
    s_nop 0
    buffer_load_dwordx4 v8, s[4:7], s30 offen lds
    s_add_u32 m0, s20, 1024
    s_nop 0
    buffer_load_dwordx4 v9, s[4:7], s30 offen lds
    s_add_u32 m0, s20, 2048
    s_nop 0
    buffer_load_dwordx4 v10, s[4:7], s30 offen lds
    s_add_u32 s29, s29, 81920
    s_add_u32 s30, s30, 128
    s_cmp_ge_u32 s30, 3456
    s_cselect_b32 s24, 2211840, 0
    s_cselect_b32 s25, 3456, 0
    s_sub_u32 s29, s29, s24
    s_sub_u32 s30, s30, s25
    s_add_u32 m0, s21, 20480
    s_nop 0
    buffer_load_dwordx4 v12, s[8:11], s29 offen lds
    s_add_u32 m0, s21, 21504
    s_nop 0
    buffer_load_dwordx4 v13, s[8:11], s29 offen lds
    s_add_u32 m0, s20, 20480
    s_nop 0
    buffer_load_dwordx4 v8, s[4:7], s30 offen lds
    s_add_u32 m0, s20, 21504
    s_nop 0
    buffer_load_dwordx4 v9, s[4:7], s30 offen lds
    s_add_u32 m0, s20, 22528
    s_nop 0
    buffer_load_dwordx4 v10, s[4:7], s30 offen lds
    s_add_u32 s29, s29, 81920
    s_add_u32 s30, s30, 128
    s_cmp_ge_u32 s30, 3456
    s_cselect_b32 s24, 2211840, 0
    s_cselect_b32 s25, 3456, 0
    s_sub_u32 s29, s29, s24
    s_sub_u32 s30, s30, s25
    s_waitcnt vmcnt(5)
    s_barrier
    s_add_u32 m0, s21, 40960
    s_nop 0
    buffer_load_dwordx4 v12, s[8:11], s29 offen lds
    s_add_u32 m0, s21, 41984
    s_nop 0
    buffer_load_dwordx4 v13, s[8:11], s29 offen lds
    s_add_u32 m0, s20, 40960
    s_nop 0
    buffer_load_dwordx4 v8, s[4:7], s30 offen lds
    s_add_u32 m0, s20, 41984
    s_nop 0
    buffer_load_dwordx4 v9, s[4:7], s30 offen lds
    s_add_u32 m0, s20, 43008
    s_nop 0
    buffer_load_dwordx4 v10, s[4:7], s30 offen lds
    s_add_u32 s29, s29, 81920
    s_add_u32 s30, s30, 128
    s_cmp_ge_u32 s30, 3456
    s_cselect_b32 s24, 2211840, 0
    s_cselect_b32 s25, 3456, 0
    s_sub_u32 s29, s29, s24
    s_sub_u32 s30, s30, s25
    s_add_u32 m0, s21, 61440
    s_nop 0
    buffer_load_dwordx4 v12, s[8:11], s29 offen lds
    s_add_u32 m0, s21, 62464
    s_nop 0
    buffer_load_dwordx4 v13, s[8:11], s29 offen lds
    s_add_u32 m0, s20, 61440
    s_nop 0
    buffer_load_dwordx4 v8, s[4:7], s30 offen lds
    s_add_u32 m0, s20, 62464
    s_nop 0
    buffer_load_dwordx4 v9, s[4:7], s30 offen lds
    s_add_u32 m0, s20, 63488
    s_nop 0
    buffer_load_dwordx4 v10, s[4:7], s30 offen lds
    s_add_u32 s29, s29, 81920
    s_add_u32 s30, s30, 128
    s_cmp_ge_u32 s30, 3456
    s_cselect_b32 s24, 2211840, 0
    s_cselect_b32 s25, 3456, 0
    s_sub_u32 s29, s29, s24
    s_sub_u32 s30, s30, s25
    s_waitcnt vmcnt(10)
    s_barrier
    s_add_u32 m0, s21, 81920
    s_nop 0
    buffer_load_dwordx4 v12, s[8:11], s29 offen lds
    s_add_u32 m0, s21, 82944
    s_nop 0
    buffer_load_dwordx4 v13, s[8:11], s29 offen lds
    s_add_u32 m0, s20, 81920
    s_nop 0
    buffer_load_dwordx4 v8, s[4:7], s30 offen lds
    s_add_u32 m0, s20, 82944
    s_nop 0
    buffer_load_dwordx4 v9, s[4:7], s30 offen lds
    s_add_u32 m0, s20, 83968
    s_nop 0
    buffer_load_dwordx4 v10, s[4:7], s30 offen lds
    s_add_u32 s29, s29, 81920
    s_add_u32 s30, s30, 128
    s_cmp_ge_u32 s30, 3456
    s_cselect_b32 s24, 2211840, 0
    s_cselect_b32 s25, 3456, 0
    s_sub_u32 s29, s29, s24
    s_sub_u32 s30, s30, s25
    s_add_u32 m0, s21, 102400
    s_nop 0
    buffer_load_dwordx4 v12, s[8:11], s29 offen lds
    s_add_u32 m0, s21, 103424
    s_nop 0
    buffer_load_dwordx4 v13, s[8:11], s29 offen lds
    s_add_u32 m0, s20, 102400
    s_nop 0
    buffer_load_dwordx4 v8, s[4:7], s30 offen lds
    s_add_u32 m0, s20, 103424
    s_nop 0
    buffer_load_dwordx4 v9, s[4:7], s30 offen lds
    s_add_u32 m0, s20, 104448
    s_nop 0
    buffer_load_dwordx4 v10, s[4:7], s30 offen lds
    s_add_u32 s29, s29, 81920
    s_add_u32 s30, s30, 128
    s_cmp_ge_u32 s30, 3456
    s_cselect_b32 s24, 2211840, 0
    s_cselect_b32 s25, 3456, 0
    s_sub_u32 s29, s29, s24
    s_sub_u32 s30, s30, s25
    s_waitcnt vmcnt(15)
    s_barrier
    s_add_u32 m0, s21, 122880
    s_nop 0
    buffer_load_dwordx4 v12, s[8:11], s29 offen lds
    s_add_u32 m0, s21, 123904
    s_nop 0
    buffer_load_dwordx4 v13, s[8:11], s29 offen lds
    s_add_u32 m0, s20, 122880
    s_nop 0
    buffer_load_dwordx4 v8, s[4:7], s30 offen lds
    s_add_u32 m0, s20, 123904
    s_nop 0
    buffer_load_dwordx4 v9, s[4:7], s30 offen lds
    s_add_u32 m0, s20, 124928
    s_nop 0
    buffer_load_dwordx4 v10, s[4:7], s30 offen lds
    s_add_u32 s29, s29, 81920
    s_add_u32 s30, s30, 128
    s_cmp_ge_u32 s30, 3456
    s_cselect_b32 s24, 2211840, 0
    s_cselect_b32 s25, 3456, 0
    s_sub_u32 s29, s29, s24
    s_sub_u32 s30, s30, s25
    s_add_u32 m0, s21, 143360
    s_nop 0
    buffer_load_dwordx4 v12, s[8:11], s29 offen lds
    s_add_u32 m0, s21, 144384
    s_nop 0
    buffer_load_dwordx4 v13, s[8:11], s29 offen lds
    s_add_u32 m0, s20, 143360
    s_nop 0
    buffer_load_dwordx4 v8, s[4:7], s30 offen lds
    s_add_u32 m0, s20, 144384
    s_nop 0
    buffer_load_dwordx4 v9, s[4:7], s30 offen lds
    s_add_u32 m0, s20, 145408
    s_nop 0
    buffer_load_dwordx4 v10, s[4:7], s30 offen lds
    s_add_u32 s29, s29, 81920
    s_add_u32 s30, s30, 128
    s_cmp_ge_u32 s30, 3456
    s_cselect_b32 s24, 2211840, 0
    s_cselect_b32 s25, 3456, 0
    s_sub_u32 s29, s29, s24
    s_sub_u32 s30, s30, s25
    s_waitcnt vmcnt(20)
    s_barrier
    s_add_u32 m0, s21, 0
    s_nop 0
    buffer_load_dwordx4 v12, s[8:11], s29 offen lds
    s_add_u32 m0, s21, 1024
    s_nop 0
    buffer_load_dwordx4 v13, s[8:11], s29 offen lds
    s_add_u32 m0, s20, 0
    s_nop 0
    buffer_load_dwordx4 v8, s[4:7], s30 offen lds
    s_add_u32 m0, s20, 1024
    s_nop 0
    buffer_load_dwordx4 v9, s[4:7], s30 offen lds
    s_add_u32 m0, s20, 2048
    s_nop 0
    buffer_load_dwordx4 v10, s[4:7], s30 offen lds
    s_add_u32 s29, s29, 81920
    s_add_u32 s30, s30, 128
    s_cmp_ge_u32 s30, 3456
    s_cselect_b32 s24, 2211840, 0
    s_cselect_b32 s25, 3456, 0
    s_sub_u32 s29, s29, s24
    s_sub_u32 s30, s30, s25
    s_add_u32 m0, s21, 20480
    s_nop 0
    buffer_load_dwordx4 v12, s[8:11], s29 offen lds
    s_add_u32 m0, s21, 21504
    s_nop 0
    buffer_load_dwordx4 v13, s[8:11], s29 offen lds
    s_add_u32 m0, s20, 20480
    s_nop 0
    buffer_load_dwordx4 v8, s[4:7], s30 offen lds
    s_add_u32 m0, s20, 21504
    s_nop 0
    buffer_load_dwordx4 v9, s[4:7], s30 offen lds
    s_add_u32 m0, s20, 22528
    s_nop 0
    buffer_load_dwordx4 v10, s[4:7], s30 offen lds
    s_add_u32 s29, s29, 81920
    s_add_u32 s30, s30, 128
    s_cmp_ge_u32 s30, 3456
    s_cselect_b32 s24, 2211840, 0
    s_cselect_b32 s25, 3456, 0
    s_sub_u32 s29, s29, s24
    s_sub_u32 s30, s30, s25
    s_waitcnt vmcnt(25)
    s_barrier
    s_add_u32 m0, s21, 40960
    s_nop 0
    buffer_load_dwordx4 v12, s[8:11], s29 offen lds
    s_add_u32 m0, s21, 41984
    s_nop 0
    buffer_load_dwordx4 v13, s[8:11], s29 offen lds
    s_add_u32 m0, s20, 40960
    s_nop 0
    buffer_load_dwordx4 v8, s[4:7], s30 offen lds
    s_add_u32 m0, s20, 41984
    s_nop 0
    buffer_load_dwordx4 v9, s[4:7], s30 offen lds
    s_add_u32 m0, s20, 43008
    s_nop 0
    buffer_load_dwordx4 v10, s[4:7], s30 offen lds
    s_add_u32 s29, s29, 81920
    s_add_u32 s30, s30, 128
    s_cmp_ge_u32 s30, 3456
    s_cselect_b32 s24, 2211840, 0
    s_cselect_b32 s25, 3456, 0
    s_sub_u32 s29, s29, s24
    s_sub_u32 s30, s30, s25
    s_waitcnt vmcnt(25)
    s_barrier
    s_add_u32 m0, s21, 61440
    s_nop 0
    buffer_load_dwordx4 v12, s[8:11], s29 offen lds
    s_add_u32 m0, s21, 62464
    s_nop 0
    buffer_load_dwordx4 v13, s[8:11], s29 offen lds
    s_add_u32 m0, s20, 61440
    s_nop 0
    buffer_load_dwordx4 v8, s[4:7], s30 offen lds
    s_add_u32 m0, s20, 62464
    s_nop 0
    buffer_load_dwordx4 v9, s[4:7], s30 offen lds
    s_add_u32 m0, s20, 63488
    s_nop 0
    buffer_load_dwordx4 v10, s[4:7], s30 offen lds
    s_add_u32 s29, s29, 81920
    s_add_u32 s30, s30, 128
    s_cmp_ge_u32 s30, 3456
    s_cselect_b32 s24, 2211840, 0
    s_cselect_b32 s25, 3456, 0
    s_sub_u32 s29, s29, s24
    s_sub_u32 s30, s30, s25
    s_waitcnt vmcnt(25)
    s_barrier
    s_add_u32 m0, s21, 81920
    s_nop 0
    buffer_load_dwordx4 v12, s[8:11], s29 offen lds
    s_add_u32 m0, s21, 82944
    s_nop 0
    buffer_load_dwordx4 v13, s[8:11], s29 offen lds
    s_add_u32 m0, s20, 81920
    s_nop 0
    buffer_load_dwordx4 v8, s[4:7], s30 offen lds
    s_add_u32 m0, s20, 82944
    s_nop 0
    buffer_load_dwordx4 v9, s[4:7], s30 offen lds
    s_add_u32 m0, s20, 83968
    s_nop 0
    buffer_load_dwordx4 v10, s[4:7], s30 offen lds
    s_add_u32 s29, s29, 81920
    s_add_u32 s30, s30, 128
    s_cmp_ge_u32 s30, 3456
    s_cselect_b32 s24, 2211840, 0
    s_cselect_b32 s25, 3456, 0
    s_sub_u32 s29, s29, s24
    s_sub_u32 s30, s30, s25
    s_waitcnt vmcnt(25)
    s_barrier
    s_add_u32 m0, s21, 102400
    s_nop 0
    buffer_load_dwordx4 v12, s[8:11], s29 offen lds
    s_add_u32 m0, s21, 103424
    s_nop 0
    buffer_load_dwordx4 v13, s[8:11], s29 offen lds
    s_add_u32 m0, s20, 102400
    s_nop 0
    buffer_load_dwordx4 v8, s[4:7], s30 offen lds
    s_add_u32 m0, s20, 103424
    s_nop 0
    buffer_load_dwordx4 v9, s[4:7], s30 offen lds
    s_add_u32 m0, s20, 104448
    s_nop 0
    buffer_load_dwordx4 v10, s[4:7], s30 offen lds
    s_add_u32 s29, s29, 81920
    s_add_u32 s30, s30, 128
    s_cmp_ge_u32 s30, 3456
    s_cselect_b32 s24, 2211840, 0
    s_cselect_b32 s25, 3456, 0
    s_sub_u32 s29, s29, s24
    s_sub_u32 s30, s30, s25
    s_waitcnt vmcnt(25)
    s_barrier
    s_add_u32 m0, s21, 122880
    s_nop 0
    buffer_load_dwordx4 v12, s[8:11], s29 offen lds
    s_add_u32 m0, s21, 123904
    s_nop 0
    buffer_load_dwordx4 v13, s[8:11], s29 offen lds
    s_add_u32 m0, s20, 122880
    s_nop 0
    buffer_load_dwordx4 v8, s[4:7], s30 offen lds
    s_add_u32 m0, s20, 123904
    s_nop 0
    buffer_load_dwordx4 v9, s[4:7], s30 offen lds
    s_add_u32 m0, s20, 124928
    s_nop 0
    buffer_load_dwordx4 v10, s[4:7], s30 offen lds
    s_add_u32 s29, s29, 81920
    s_add_u32 s30, s30, 128
    s_cmp_ge_u32 s30, 3456
    s_cselect_b32 s24, 2211840, 0
    s_cselect_b32 s25, 3456, 0
    s_sub_u32 s29, s29, s24
    s_sub_u32 s30, s30, s25
    s_waitcnt vmcnt(25)
    s_barrier
    s_add_u32 m0, s21, 143360
    s_nop 0
    buffer_load_dwordx4 v12, s[8:11], s29 offen lds
    s_add_u32 m0, s21, 144384
    s_nop 0
    buffer_load_dwordx4 v13, s[8:11], s29 offen lds
    s_add_u32 m0, s20, 143360
    s_nop 0
    buffer_load_dwordx4 v8, s[4:7], s30 offen lds
    s_add_u32 m0, s20, 144384
    s_nop 0
    buffer_load_dwordx4 v9, s[4:7], s30 offen lds
    s_add_u32 m0, s20, 145408
    s_nop 0
    buffer_load_dwordx4 v10, s[4:7], s30 offen lds
    s_add_u32 s29, s29, 81920
    s_add_u32 s30, s30, 128
    s_cmp_ge_u32 s30, 3456
    s_cselect_b32 s24, 2211840, 0
    s_cselect_b32 s25, 3456, 0
    s_sub_u32 s29, s29, s24
    s_sub_u32 s30, s30, s25
    s_waitcnt vmcnt(25)
    s_barrier
    s_add_u32 m0, s21, 0
    s_nop 0
    buffer_load_dwordx4 v12, s[8:11], s29 offen lds
    s_add_u32 m0, s21, 1024
    s_nop 0
    buffer_load_dwordx4 v13, s[8:11], s29 offen lds
    s_add_u32 m0, s20, 0
    s_nop 0
    buffer_load_dwordx4 v8, s[4:7], s30 offen lds
    s_add_u32 m0, s20, 1024
    s_nop 0
    buffer_load_dwordx4 v9, s[4:7], s30 offen lds
    s_add_u32 m0, s20, 2048
    s_nop 0
    buffer_load_dwordx4 v10, s[4:7], s30 offen lds
    s_add_u32 s29, s29, 81920
    s_add_u32 s30, s30, 128
    s_cmp_ge_u32 s30, 3456
    s_cselect_b32 s24, 2211840, 0
    s_cselect_b32 s25, 3456, 0
    s_sub_u32 s29, s29, s24
    s_sub_u32 s30, s30, s25
    s_waitcnt vmcnt(25)
    s_barrier
    s_add_u32 m0, s21, 20480
    s_nop 0
    buffer_load_dwordx4 v12, s[8:11], s29 offen lds
    s_add_u32 m0, s21, 21504
    s_nop 0
    buffer_load_dwordx4 v13, s[8:11], s29 offen lds
    s_add_u32 m0, s20, 20480
    s_nop 0
    buffer_load_dwordx4 v8, s[4:7], s30 offen lds
    s_add_u32 m0, s20, 21504
    s_nop 0
    buffer_load_dwordx4 v9, s[4:7], s30 offen lds
    s_add_u32 m0, s20, 22528
    s_nop 0
    buffer_load_dwordx4 v10, s[4:7], s30 offen lds
    s_add_u32 s29, s29, 81920
    s_add_u32 s30, s30, 128
    s_cmp_ge_u32 s30, 3456
    s_cselect_b32 s24, 2211840, 0
    s_cselect_b32 s25, 3456, 0
    s_sub_u32 s29, s29, s24
    s_sub_u32 s30, s30, s25
    s_waitcnt vmcnt(25)
    s_barrier
    s_add_u32 m0, s21, 40960
    s_nop 0
    buffer_load_dwordx4 v12, s[8:11], s29 offen lds
    s_add_u32 m0, s21, 41984
    s_nop 0
    buffer_load_dwordx4 v13, s[8:11], s29 offen lds
    s_add_u32 m0, s20, 40960
    s_nop 0
    buffer_load_dwordx4 v8, s[4:7], s30 offen lds
    s_add_u32 m0, s20, 41984
    s_nop 0
    buffer_load_dwordx4 v9, s[4:7], s30 offen lds
    s_add_u32 m0, s20, 43008
    s_nop 0
    buffer_load_dwordx4 v10, s[4:7], s30 offen lds
    s_add_u32 s29, s29, 81920
    s_add_u32 s30, s30, 128
    s_cmp_ge_u32 s30, 3456
    s_cselect_b32 s24, 2211840, 0
    s_cselect_b32 s25, 3456, 0
    s_sub_u32 s29, s29, s24
    s_sub_u32 s30, s30, s25
    s_waitcnt vmcnt(25)
    s_barrier
    s_add_u32 m0, s21, 61440
    s_nop 0
    buffer_load_dwordx4 v12, s[8:11], s29 offen lds
    s_add_u32 m0, s21, 62464
    s_nop 0
    buffer_load_dwordx4 v13, s[8:11], s29 offen lds
    s_add_u32 m0, s20, 61440
    s_nop 0
    buffer_load_dwordx4 v8, s[4:7], s30 offen lds
    s_add_u32 m0, s20, 62464
    s_nop 0
    buffer_load_dwordx4 v9, s[4:7], s30 offen lds
    s_add_u32 m0, s20, 63488
    s_nop 0
    buffer_load_dwordx4 v10, s[4:7], s30 offen lds
    s_add_u32 s29, s29, 81920
    s_add_u32 s30, s30, 128
    s_cmp_ge_u32 s30, 3456
    s_cselect_b32 s24, 2211840, 0
    s_cselect_b32 s25, 3456, 0
    s_sub_u32 s29, s29, s24
    s_sub_u32 s30, s30, s25
    s_waitcnt vmcnt(25)
    s_barrier
    s_add_u32 m0, s21, 81920
    s_nop 0
    buffer_load_dwordx4 v12, s[8:11], s29 offen lds
    s_add_u32 m0, s21, 82944
    s_nop 0
    buffer_load_dwordx4 v13, s[8:11], s29 offen lds
    s_add_u32 m0, s20, 81920
    s_nop 0
    buffer_load_dwordx4 v8, s[4:7], s30 offen lds
    s_add_u32 m0, s20, 82944
    s_nop 0
    buffer_load_dwordx4 v9, s[4:7], s30 offen lds
    s_add_u32 m0, s20, 83968
    s_nop 0
    buffer_load_dwordx4 v10, s[4:7], s30 offen lds
    s_add_u32 s29, s29, 81920
    s_add_u32 s30, s30, 128
    s_cmp_ge_u32 s30, 3456
    s_cselect_b32 s24, 2211840, 0
    s_cselect_b32 s25, 3456, 0
    s_sub_u32 s29, s29, s24
    s_sub_u32 s30, s30, s25
    s_waitcnt vmcnt(25)
    s_barrier
    s_add_u32 m0, s21, 102400
    s_nop 0
    buffer_load_dwordx4 v12, s[8:11], s29 offen lds
    s_add_u32 m0, s21, 103424
    s_nop 0
    buffer_load_dwordx4 v13, s[8:11], s29 offen lds
    s_add_u32 m0, s20, 102400
    s_nop 0
    buffer_load_dwordx4 v8, s[4:7], s30 offen lds
    s_add_u32 m0, s20, 103424
    s_nop 0
    buffer_load_dwordx4 v9, s[4:7], s30 offen lds
    s_add_u32 m0, s20, 104448
    s_nop 0
    buffer_load_dwordx4 v10, s[4:7], s30 offen lds
    s_add_u32 s29, s29, 81920
    s_add_u32 s30, s30, 128
    s_cmp_ge_u32 s30, 3456
    s_cselect_b32 s24, 2211840, 0
    s_cselect_b32 s25, 3456, 0
    s_sub_u32 s29, s29, s24
    s_sub_u32 s30, s30, s25
    s_waitcnt vmcnt(25)
    s_barrier
    s_add_u32 m0, s21, 122880
    s_nop 0
    buffer_load_dwordx4 v12, s[8:11], s29 offen lds
    s_add_u32 m0, s21, 123904
    s_nop 0
    buffer_load_dwordx4 v13, s[8:11], s29 offen lds
    s_add_u32 m0, s20, 122880
    s_nop 0
    buffer_load_dwordx4 v8, s[4:7], s30 offen lds
    s_add_u32 m0, s20, 123904
    s_nop 0
    buffer_load_dwordx4 v9, s[4:7], s30 offen lds
    s_add_u32 m0, s20, 124928
    s_nop 0
    buffer_load_dwordx4 v10, s[4:7], s30 offen lds
    s_add_u32 s29, s29, 81920
    s_add_u32 s30, s30, 128
    s_cmp_ge_u32 s30, 3456
    s_cselect_b32 s24, 2211840, 0
    s_cselect_b32 s25, 3456, 0
    s_sub_u32 s29, s29, s24
    s_sub_u32 s30, s30, s25
    s_waitcnt vmcnt(25)
    s_barrier
    s_add_u32 m0, s21, 143360
    s_nop 0
    buffer_load_dwordx4 v12, s[8:11], s29 offen lds
    s_add_u32 m0, s21, 144384
    s_nop 0
    buffer_load_dwordx4 v13, s[8:11], s29 offen lds
    s_add_u32 m0, s20, 143360
    s_nop 0
    buffer_load_dwordx4 v8, s[4:7], s30 offen lds
    s_add_u32 m0, s20, 144384
    s_nop 0
    buffer_load_dwordx4 v9, s[4:7], s30 offen lds
    s_add_u32 m0, s20, 145408
    s_nop 0
    buffer_load_dwordx4 v10, s[4:7], s30 offen lds
    s_add_u32 s29, s29, 81920
    s_add_u32 s30, s30, 128
    s_cmp_ge_u32 s30, 3456
    s_cselect_b32 s24, 2211840, 0
    s_cselect_b32 s25, 3456, 0
    s_sub_u32 s29, s29, s24
    s_sub_u32 s30, s30, s25
    s_waitcnt vmcnt(25)
    s_barrier
    s_add_u32 m0, s21, 0
    s_nop 0
    buffer_load_dwordx4 v12, s[8:11], s29 offen lds
    s_add_u32 m0, s21, 1024
    s_nop 0
    buffer_load_dwordx4 v13, s[8:11], s29 offen lds
    s_add_u32 m0, s20, 0
    s_nop 0
    buffer_load_dwordx4 v8, s[4:7], s30 offen lds
    s_add_u32 m0, s20, 1024
    s_nop 0
    buffer_load_dwordx4 v9, s[4:7], s30 offen lds
    s_add_u32 m0, s20, 2048
    s_nop 0
    buffer_load_dwordx4 v10, s[4:7], s30 offen lds
    s_add_u32 s29, s29, 81920
    s_add_u32 s30, s30, 128
    s_cmp_ge_u32 s30, 3456
    s_cselect_b32 s24, 2211840, 0
    s_cselect_b32 s25, 3456, 0
    s_sub_u32 s29, s29, s24
    s_sub_u32 s30, s30, s25
    s_waitcnt vmcnt(25)
    s_barrier
    s_add_u32 m0, s21, 20480
    s_nop 0
    buffer_load_dwordx4 v12, s[8:11], s29 offen lds
    s_add_u32 m0, s21, 21504
    s_nop 0
    buffer_load_dwordx4 v13, s[8:11], s29 offen lds
    s_add_u32 m0, s20, 20480
    s_nop 0
    buffer_load_dwordx4 v8, s[4:7], s30 offen lds
    s_add_u32 m0, s20, 21504
    s_nop 0
    buffer_load_dwordx4 v9, s[4:7], s30 offen lds
    s_add_u32 m0, s20, 22528
    s_nop 0
    buffer_load_dwordx4 v10, s[4:7], s30 offen lds
    s_add_u32 s29, s29, 81920
    s_add_u32 s30, s30, 128
    s_cmp_ge_u32 s30, 3456
    s_cselect_b32 s24, 2211840, 0
    s_cselect_b32 s25, 3456, 0
    s_sub_u32 s29, s29, s24
    s_sub_u32 s30, s30, s25
    s_waitcnt vmcnt(25)
    s_barrier
    s_add_u32 m0, s21, 40960
    s_nop 0
    buffer_load_dwordx4 v12, s[8:11], s29 offen lds
    s_add_u32 m0, s21, 41984
    s_nop 0
    buffer_load_dwordx4 v13, s[8:11], s29 offen lds
    s_add_u32 m0, s20, 40960
    s_nop 0
    buffer_load_dwordx4 v8, s[4:7], s30 offen lds
    s_add_u32 m0, s20, 41984
    s_nop 0
    buffer_load_dwordx4 v9, s[4:7], s30 offen lds
    s_add_u32 m0, s20, 43008
    s_nop 0
    buffer_load_dwordx4 v10, s[4:7], s30 offen lds
    s_waitcnt vmcnt(25)
    s_barrier
    s_waitcnt vmcnt(20)
    s_barrier
    s_waitcnt vmcnt(15)
    s_barrier
    s_waitcnt vmcnt(10)
    s_barrier
    s_waitcnt vmcnt(5)
    s_barrier
    s_waitcnt vmcnt(0)
    s_barrier
L_ffn2_kernel_end:
    s_endpgm
.section .rodata,"a"
.p2align 6
.amdhsa_kernel ffn2_kernel
  .amdhsa_next_free_vgpr 112
  .amdhsa_next_free_sgpr 102
  .amdhsa_accum_offset 112
  .amdhsa_group_segment_fixed_size 0
  .amdhsa_kernarg_size 64
  .amdhsa_user_sgpr_count 2
  .amdhsa_user_sgpr_kernarg_segment_ptr 1
  .amdhsa_system_sgpr_workgroup_id_x 1
.end_amdhsa_kernel
.text
```
